```python
import torch

def _softmax(x, axis=-1):
    return torch.softmax(x, dim=axis)
def _gelu(x):
    return torch.nn.functional.gelu(x, approximate="tanh")
def _silu(x):
    return torch.nn.functional.silu(x)
def _sigmoid(x):
    return torch.sigmoid(x)
def _layernorm(x, axis=-1, eps=1e-5):
    m = x.mean(dim=axis, keepdim=True)
    v = x.var(dim=axis, keepdim=True, unbiased=False)
    return (x - m) / torch.sqrt(v + eps)
def _scatter_add(tgt, idx, src, axis=0):
    return tgt.clone().index_add_(axis, idx, src)
def _segment_sum(src, seg, n):
    out = torch.zeros((n,) + src.shape[1:], dtype=src.dtype)
    return out.index_add_(0, seg, src)
def _pad(x, pw):
    flat = tuple(v for pair in reversed(pw) for v in pair)
    return torch.nn.functional.pad(x, flat)

kernel_name = 'recurrent_scan__softmax_full_mha__dense_activation_relu__prompt'

def setup_inputs():

    _w = (lambda a: (lambda t: t.to(torch.bfloat16) if t.is_floating_point() else t)(torch.as_tensor(a)))
    def _A_setup():
        B, S, D = 1, 2048, 512
        return {
            "x": _w((lambda *s: torch.randn(*s, dtype=torch.bfloat16) * 0.05)(B, S, D)),
            "wqkv": _w((lambda *s: torch.randn(*s, dtype=torch.bfloat16) * 0.05)(D, 3 * D)),
            "wo": _w((lambda *s: torch.randn(*s, dtype=torch.bfloat16) * 0.05)(D, D)),
        }
    _A_in = _A_setup()

    def _B_setup():
        B, S, D, Dff = 1, 2048, 512, 1376
        return {
            "x": _w((lambda *s: torch.randn(*s, dtype=torch.bfloat16) * 0.05)(B, S, D)),
            "w1": _w((lambda *s: torch.randn(*s, dtype=torch.bfloat16) * 0.05)(D, Dff)),
            "w2": _w((lambda *s: torch.randn(*s, dtype=torch.bfloat16) * 0.05)(Dff, D)),
        }
    _B_in = _B_setup()

    return {
        "A_x": _A_in["x"],
        "A_wqkv": _A_in["wqkv"],
        "A_wo": _A_in["wo"],
        "B_x": _B_in["x"],
        "B_w1": _B_in["w1"],
        "B_w2": _B_in["w2"],
    }

def reference(A_x, A_wqkv, A_wo, B_x, B_w1, B_w2):
    def _A_ref(x, wqkv, wo):
        B, S, D = x.shape
        H = 32; Dh = D // H
        qkv = (lambda x, *d: x.permute(*d))((x @ wqkv).reshape(B, S, 3, H, Dh), 2, 0, 3, 1, 4)
        q, k, v = qkv[0], qkv[1], qkv[2]
        scale = Dh ** -0.5
        scores = torch.einsum("bhqd,bhkd->bhqk", q, k) * scale
        p = _softmax(scores, axis=-1)
        o = torch.einsum("bhqk,bhkd->bhqd", p, v)
        return (lambda x, *d: x.permute(*d))(o, 0, 2, 1, 3).reshape(B, S, D) @ wo

    def _B_ref(x, w1, w2):
        h = torch.einsum("bsd,df->bsf", x, w1)
        zero = torch.zeros_like(h)
        h = torch.maximum(h, zero)
        return torch.einsum("bsf,fd->bsd", h, w2)

    x = A_x
    xn = _layernorm(x, axis=-1)
    s = _A_ref(xn, A_wqkv, A_wo)
    g = _silu(_B_ref(xn, B_w1, B_w2))
    return x + s * g
```

```asm
; @launch grid=(256,1,1) block=(768,1,1) lds=163840
.amdgcn_target "amdgcn-amd-amdhsa--gfx950"
.text
.globl recurrent_scan__softmax_full_mha__dense_activation_relu__prompt_kernel
.p2align 8
.type recurrent_scan__softmax_full_mha__dense_activation_relu__prompt_kernel,@function
recurrent_scan__softmax_full_mha__dense_activation_relu__prompt_kernel:
    s_cmp_ge_u32 s2, 256
    s_cbranch_scc1 L_end_1
    s_load_dwordx4 s[4:7], s[0:1], 0
    s_load_dwordx2 s[8:9], s[0:1], 64
    s_load_dwordx4 s[72:75], s[0:1], 32
    s_load_dwordx2 s[76:77], s[0:1], 16
    s_load_dwordx2 s[10:11], s[0:1], 48
    v_and_b32 v1, 63, v0
    v_lshrrev_b32 v11, 6, v0
    s_and_b32 s25, s2, 7
    v_readfirstlane_b32 s24, v11
    s_lshr_b32 s26, s2, 3
    s_cmp_ge_u32 s2, 16
    s_cbranch_scc1 L_code_4
    s_cmp_lt_u32 s24, 8
    s_cbranch_scc1 L_code_4
    s_getpc_b64 s[38:39]
L_code_pc:
    v_subrev_u32 v15, 512, v0
    v_lshlrev_b32 v15, 7, v15
    v_min_u32 v15, L_code_end - L_code_pc - 4, v15
    global_load_dword v22, v15, s[38:39]
L_code_4:
    s_and_b32 s78, s25, 3
    s_lshl_b32 s78, s78, 3
    s_and_b32 s79, s26, 7
    s_add_u32 s78, s78, s79
    s_and_b32 s79, s25, 4
    s_lshr_b32 s29, s26, 3
    s_add_u32 s79, s79, s29
    s_lshl_b32 s55, s29, 1
    s_add_u32 s55, s55, s26
    s_and_b32 s55, s55, 7
    v_lshrrev_b32 v11, 3, v1
    v_and_b32 v12, 7, v1
    v_lshlrev_b32 v2, 10, v11
    v_lshl_add_u32 v2, v12, 4, v2
    s_lshl_b32 s27, s25, 2
    s_and_b32 s28, s26, 3
    s_add_u32 s27, s27, s28
    s_lshr_b32 s28, s26, 2
    s_lshl_b32 s30, s78, 16
    s_lshl_b32 s31, s24, 13
    s_add_u32 s30, s30, s31
    s_waitcnt lgkmcnt(0)
    s_mov_b32 s60, s4
    s_mov_b32 s61, s5
    s_mov_b32 s62, 0x200000
    s_mov_b32 s63, 0x00020000
    s_cmp_ge_u32 s24, 8
    s_cbranch_scc1 L_ld_2
    s_add_u32 s31, s55, 0
    s_and_b32 s31, s31, 7
    s_lshl_b32 s31, s31, 7
    s_add_u32 s31, s31, s30
    buffer_load_dwordx4 v[32:35], v2, s[60:63], s31 offen
    s_add_u32 s31, s55, 1
    s_and_b32 s31, s31, 7
    s_lshl_b32 s31, s31, 7
    s_add_u32 s31, s31, s30
    buffer_load_dwordx4 v[36:39], v2, s[60:63], s31 offen
    s_add_u32 s31, s55, 2
    s_and_b32 s31, s31, 7
    s_lshl_b32 s31, s31, 7
    s_add_u32 s31, s31, s30
    buffer_load_dwordx4 v[40:43], v2, s[60:63], s31 offen
    s_add_u32 s31, s55, 3
    s_and_b32 s31, s31, 7
    s_lshl_b32 s31, s31, 7
    s_add_u32 s31, s31, s30
    buffer_load_dwordx4 v[44:47], v2, s[60:63], s31 offen
    s_add_u32 s31, s55, 4
    s_and_b32 s31, s31, 7
    s_lshl_b32 s31, s31, 7
    s_add_u32 s31, s31, s30
    buffer_load_dwordx4 v[48:51], v2, s[60:63], s31 offen
    s_add_u32 s31, s55, 5
    s_and_b32 s31, s31, 7
    s_lshl_b32 s31, s31, 7
    s_add_u32 s31, s31, s30
    buffer_load_dwordx4 v[52:55], v2, s[60:63], s31 offen
    s_add_u32 s31, s55, 6
    s_and_b32 s31, s31, 7
    s_lshl_b32 s31, s31, 7
    s_add_u32 s31, s31, s30
    buffer_load_dwordx4 v[56:59], v2, s[60:63], s31 offen
    s_add_u32 s31, s55, 7
    s_and_b32 s31, s31, 7
    s_lshl_b32 s31, s31, 7
    s_add_u32 s31, s31, s30
    buffer_load_dwordx4 v[60:63], v2, s[60:63], s31 offen
    s_barrier
    s_branch L_ln2_5
L_ld_2:
    s_mov_b32 s12, s6
    s_mov_b32 s13, s7
    s_mov_b32 s14, 0x180000
    s_mov_b32 s15, 0x00020000
    v_lshrrev_b32 v13, 2, v1
    v_and_b32 v13, 4, v13
    v_xor_b32 v13, v12, v13
    v_mul_u32_u24 v3, 3072, v11
    v_lshl_add_u32 v3, v13, 4, v3
    s_sub_u32 s29, s24, 8
    s_mul_i32 s33, s29, 6144
    s_mul_i32 s32, s29, 49152
    s_lshl_b32 s34, s79, 7
    s_add_u32 s32, s32, s34
    s_barrier
    s_add_u32 s34, s55, 0
    s_and_b32 s34, s34, 7
    s_mul_i32 s34, s34, 196608
    s_add_u32 m0, s33, 49152
    s_add_u32 s34, s34, s32
    buffer_load_dwordx4 v3, s[12:15], s34 offen offset:0 lds
    buffer_load_dwordx4 v3, s[12:15], s34 offen offset:1024 lds
    buffer_load_dwordx4 v3, s[12:15], s34 offen offset:2048 lds
    s_add_u32 m0, s33, 52224
    s_add_u32 s34, s34, 24576
    buffer_load_dwordx4 v3, s[12:15], s34 offen offset:0 lds
    buffer_load_dwordx4 v3, s[12:15], s34 offen offset:1024 lds
    buffer_load_dwordx4 v3, s[12:15], s34 offen offset:2048 lds
    s_add_u32 s34, s55, 1
    s_and_b32 s34, s34, 7
    s_mul_i32 s34, s34, 196608
    s_add_u32 m0, s33, 73728
    s_add_u32 s34, s34, s32
    buffer_load_dwordx4 v3, s[12:15], s34 offen offset:0 lds
    buffer_load_dwordx4 v3, s[12:15], s34 offen offset:1024 lds
    buffer_load_dwordx4 v3, s[12:15], s34 offen offset:2048 lds
    s_add_u32 m0, s33, 76800
    s_add_u32 s34, s34, 24576
    buffer_load_dwordx4 v3, s[12:15], s34 offen offset:0 lds
    buffer_load_dwordx4 v3, s[12:15], s34 offen offset:1024 lds
    buffer_load_dwordx4 v3, s[12:15], s34 offen offset:2048 lds
    s_add_u32 s34, s55, 2
    s_and_b32 s34, s34, 7
    s_mul_i32 s34, s34, 196608
    s_add_u32 m0, s33, 0
    s_add_u32 s34, s34, s32
    buffer_load_dwordx4 v3, s[12:15], s34 offen offset:0 lds
    buffer_load_dwordx4 v3, s[12:15], s34 offen offset:1024 lds
    buffer_load_dwordx4 v3, s[12:15], s34 offen offset:2048 lds
    s_add_u32 m0, s33, 3072
    s_add_u32 s34, s34, 24576
    buffer_load_dwordx4 v3, s[12:15], s34 offen offset:0 lds
    buffer_load_dwordx4 v3, s[12:15], s34 offen offset:1024 lds
    buffer_load_dwordx4 v3, s[12:15], s34 offen offset:2048 lds
    s_mov_b32 s20, s8
    s_mov_b32 s21, s9
    s_mov_b32 s22, 0x2000000
    s_mov_b32 s23, 0x00020000
    s_waitcnt vmcnt(12)
    s_barrier
    s_add_u32 s34, s55, 3
    s_and_b32 s34, s34, 7
    s_mul_i32 s34, s34, 196608
    s_add_u32 m0, s33, 24576
    s_add_u32 s34, s34, s32
    buffer_load_dwordx4 v3, s[12:15], s34 offen offset:0 lds
    buffer_load_dwordx4 v3, s[12:15], s34 offen offset:1024 lds
    buffer_load_dwordx4 v3, s[12:15], s34 offen offset:2048 lds
    s_add_u32 m0, s33, 27648
    s_add_u32 s34, s34, 24576
    buffer_load_dwordx4 v3, s[12:15], s34 offen offset:0 lds
    buffer_load_dwordx4 v3, s[12:15], s34 offen offset:1024 lds
    buffer_load_dwordx4 v3, s[12:15], s34 offen offset:2048 lds
    s_waitcnt vmcnt(12)
    s_barrier
    s_waitcnt vmcnt(6)
    s_barrier
    s_add_u32 s34, s55, 4
    s_and_b32 s34, s34, 7
    s_mul_i32 s34, s34, 196608
    s_add_u32 m0, s33, 49152
    s_add_u32 s34, s34, s32
    buffer_load_dwordx4 v3, s[12:15], s34 offen offset:0 lds
    buffer_load_dwordx4 v3, s[12:15], s34 offen offset:1024 lds
    buffer_load_dwordx4 v3, s[12:15], s34 offen offset:2048 lds
    s_add_u32 m0, s33, 52224
    s_add_u32 s34, s34, 24576
    buffer_load_dwordx4 v3, s[12:15], s34 offen offset:0 lds
    buffer_load_dwordx4 v3, s[12:15], s34 offen offset:1024 lds
    buffer_load_dwordx4 v3, s[12:15], s34 offen offset:2048 lds
    s_waitcnt vmcnt(6)
    s_barrier
    s_add_u32 s34, s55, 5
    s_and_b32 s34, s34, 7
    s_mul_i32 s34, s34, 196608
    s_add_u32 m0, s33, 73728
    s_add_u32 s34, s34, s32
    buffer_load_dwordx4 v3, s[12:15], s34 offen offset:0 lds
    buffer_load_dwordx4 v3, s[12:15], s34 offen offset:1024 lds
    buffer_load_dwordx4 v3, s[12:15], s34 offen offset:2048 lds
    s_add_u32 m0, s33, 76800
    s_add_u32 s34, s34, 24576
    buffer_load_dwordx4 v3, s[12:15], s34 offen offset:0 lds
    buffer_load_dwordx4 v3, s[12:15], s34 offen offset:1024 lds
    buffer_load_dwordx4 v3, s[12:15], s34 offen offset:2048 lds
    s_waitcnt vmcnt(6)
    s_barrier
    s_add_u32 s34, s55, 6
    s_and_b32 s34, s34, 7
    s_mul_i32 s34, s34, 196608
    s_add_u32 m0, s33, 0
    s_add_u32 s34, s34, s32
    buffer_load_dwordx4 v3, s[12:15], s34 offen offset:0 lds
    buffer_load_dwordx4 v3, s[12:15], s34 offen offset:1024 lds
    buffer_load_dwordx4 v3, s[12:15], s34 offen offset:2048 lds
    s_add_u32 m0, s33, 3072
    s_add_u32 s34, s34, 24576
    buffer_load_dwordx4 v3, s[12:15], s34 offen offset:0 lds
    buffer_load_dwordx4 v3, s[12:15], s34 offen offset:1024 lds
    buffer_load_dwordx4 v3, s[12:15], s34 offen offset:2048 lds
    s_waitcnt vmcnt(6)
    s_barrier
    s_add_u32 s34, s55, 7
    s_and_b32 s34, s34, 7
    s_mul_i32 s34, s34, 196608
    s_add_u32 m0, s33, 24576
    s_add_u32 s34, s34, s32
    buffer_load_dwordx4 v3, s[12:15], s34 offen offset:0 lds
    buffer_load_dwordx4 v3, s[12:15], s34 offen offset:1024 lds
    buffer_load_dwordx4 v3, s[12:15], s34 offen offset:2048 lds
    s_add_u32 m0, s33, 27648
    s_add_u32 s34, s34, 24576
    buffer_load_dwordx4 v3, s[12:15], s34 offen offset:0 lds
    buffer_load_dwordx4 v3, s[12:15], s34 offen offset:1024 lds
    buffer_load_dwordx4 v3, s[12:15], s34 offen offset:2048 lds
    s_waitcnt vmcnt(6)
    s_barrier
    s_waitcnt vmcnt(0)
    s_barrier
    s_barrier
    s_branch L_attpre_3
L_ln2_5:
    s_mov_b32 s20, s8
    s_mov_b32 s21, s9
    s_mov_b32 s22, 0x2000000
    s_mov_b32 s23, 0x00020000
    s_add_u32 s82, s8, 0x1404000
    s_addc_u32 s83, s9, 0
    s_load_dword s3, s[82:83], 0
    v_xor_b32 v13, v11, v12
    v_lshlrev_b32 v4, 9, v12
    v_lshl_add_u32 v4, v13, 4, v4
    s_lshr_b32 s35, s24, 2
    s_and_b32 s36, s24, 3
    s_lshl_b32 s37, s35, 12
    s_lshl_b32 s38, s36, 7
    s_add_u32 s37, s37, s38
    s_add_u32 s37, s37, 98304
    v_add_u32 v4, s37, v4
    s_bfe_u32 s46, s24, 0x10001
    s_and_b32 s47, s24, 1
    v_lshlrev_b32 v2, 4, v1
    s_and_b32 s80, s78, 7
    s_lshl_b32 s80, s80, 2
    s_lshr_b32 s51, s78, 3
    s_add_u32 s80, s80, s51
    s_cmp_lt_u32 s24, 4
    s_cbranch_scc1 L_nosetup_6
    v_and_b32 v13, 31, v1
    v_lshrrev_b32 v14, 5, v1
    s_lshl_b32 s37, s47, 12
    s_add_u32 s37, s37, 98304
    v_add_u32 v15, 0, v14
    v_xor_b32 v16, v13, v15
    v_lshlrev_b32 v16, 4, v16
    v_lshl_add_u32 v16, v15, 9, v16
    v_add_u32 v5, s37, v16
    v_add_u32 v15, 2, v14
    v_xor_b32 v16, v13, v15
    v_lshlrev_b32 v16, 4, v16
    v_lshl_add_u32 v16, v15, 9, v16
    v_add_u32 v6, s37, v16
    v_add_u32 v15, 4, v14
    v_xor_b32 v16, v13, v15
    v_lshlrev_b32 v16, 4, v16
    v_lshl_add_u32 v16, v15, 9, v16
    v_add_u32 v7, s37, v16
    v_add_u32 v15, 6, v14
    v_xor_b32 v16, v13, v15
    v_lshlrev_b32 v16, 4, v16
    v_lshl_add_u32 v16, v15, 9, v16
    v_add_u32 v8, s37, v16
    v_mul_u32_u24 v9, 3072, v14
    v_bfe_u32 v15, v1, 2, 2
    v_lshl_add_u32 v9, v15, 7, v9
    v_lshrrev_b32 v15, 1, v15
    v_xor_b32 v15, s46, v15
    v_lshl_add_u32 v9, v15, 6, v9
    v_bfe_u32 v15, v1, 4, 1
    v_lshl_add_u32 v9, v15, 5, v9
    v_and_b32 v15, 3, v1
    v_lshl_add_u32 v9, v15, 3, v9
    v_add_u32 v9, 49152, v9
    v_bfe_u32 v15, v1, 4, 1
    v_lshlrev_b32 v12, 17, v15
    v_lshl_add_u32 v12, v14, 8, v12
    v_and_b32 v15, 15, v1
    v_lshl_add_u32 v12, v15, 4, v12
    s_lshl_b32 s43, s78, 1
    s_add_u32 s43, s43, s47
    s_lshl_b32 s44, s79, 2
    s_lshl_b32 s45, s46, 1
    s_add_u32 s44, s44, s45
    s_lshl_b32 s48, s44, 16
    s_lshl_b32 s49, s43, 10
    s_add_u32 s48, s48, s49
    s_add_u32 s48, s48, 0x0
    s_add_u32 s49, s48, 65536
    s_lshl_b32 s51, s80, 1
    s_add_u32 s51, s51, s47
    s_lshl_b32 s51, s51, 11
    s_lshl_b32 s50, s44, 17
    s_add_u32 s50, s50, s51
    s_add_u32 s50, s50, 0x200000
    s_add_u32 s51, s50, 131072
    s_mov_b32 s52, 0x3eb8aa3b
    s_mov_b32 s56, 3
    s_mov_b32 s57, 24576
    s_mov_b32 s59, 0xfffee000
    s_movk_i32 s58, 0x2000
L_nosetup_6:
    v_mov_b32 v14, 0x3f803f80
    v_mov_b32 v15, 0xffff0000
    v_mov_b32 v16, 0
    v_mov_b32 v17, 0
    v_mov_b32 v18, 0
    v_mov_b32 v19, 0
    s_waitcnt vmcnt(7)
    v_dot2c_f32_bf16 v16, v14, v32
    v_dot2c_f32_bf16 v18, v32, v32
    v_dot2c_f32_bf16 v17, v14, v33
    v_dot2c_f32_bf16 v19, v33, v33
    v_dot2c_f32_bf16 v16, v14, v34
    v_dot2c_f32_bf16 v18, v34, v34
    v_dot2c_f32_bf16 v17, v14, v35
    v_dot2c_f32_bf16 v19, v35, v35
    s_waitcnt vmcnt(6)
    v_dot2c_f32_bf16 v16, v14, v36
    v_dot2c_f32_bf16 v18, v36, v36
    v_dot2c_f32_bf16 v17, v14, v37
    v_dot2c_f32_bf16 v19, v37, v37
    v_dot2c_f32_bf16 v16, v14, v38
    v_dot2c_f32_bf16 v18, v38, v38
    v_dot2c_f32_bf16 v17, v14, v39
    v_dot2c_f32_bf16 v19, v39, v39
    s_waitcnt vmcnt(5)
    v_dot2c_f32_bf16 v16, v14, v40
    v_dot2c_f32_bf16 v18, v40, v40
    v_dot2c_f32_bf16 v17, v14, v41
    v_dot2c_f32_bf16 v19, v41, v41
    v_dot2c_f32_bf16 v16, v14, v42
    v_dot2c_f32_bf16 v18, v42, v42
    v_dot2c_f32_bf16 v17, v14, v43
    v_dot2c_f32_bf16 v19, v43, v43
    s_waitcnt vmcnt(4)
    v_dot2c_f32_bf16 v16, v14, v44
    v_dot2c_f32_bf16 v18, v44, v44
    v_dot2c_f32_bf16 v17, v14, v45
    v_dot2c_f32_bf16 v19, v45, v45
    v_dot2c_f32_bf16 v16, v14, v46
    v_dot2c_f32_bf16 v18, v46, v46
    v_dot2c_f32_bf16 v17, v14, v47
    v_dot2c_f32_bf16 v19, v47, v47
    s_waitcnt vmcnt(3)
    v_dot2c_f32_bf16 v16, v14, v48
    v_dot2c_f32_bf16 v18, v48, v48
    v_dot2c_f32_bf16 v17, v14, v49
    v_dot2c_f32_bf16 v19, v49, v49
    v_dot2c_f32_bf16 v16, v14, v50
    v_dot2c_f32_bf16 v18, v50, v50
    v_dot2c_f32_bf16 v17, v14, v51
    v_dot2c_f32_bf16 v19, v51, v51
    s_waitcnt vmcnt(2)
    v_dot2c_f32_bf16 v16, v14, v52
    v_dot2c_f32_bf16 v18, v52, v52
    v_dot2c_f32_bf16 v17, v14, v53
    v_dot2c_f32_bf16 v19, v53, v53
    v_dot2c_f32_bf16 v16, v14, v54
    v_dot2c_f32_bf16 v18, v54, v54
    v_dot2c_f32_bf16 v17, v14, v55
    v_dot2c_f32_bf16 v19, v55, v55
    s_waitcnt vmcnt(1)
    v_dot2c_f32_bf16 v16, v14, v56
    v_dot2c_f32_bf16 v18, v56, v56
    v_dot2c_f32_bf16 v17, v14, v57
    v_dot2c_f32_bf16 v19, v57, v57
    v_dot2c_f32_bf16 v16, v14, v58
    v_dot2c_f32_bf16 v18, v58, v58
    v_dot2c_f32_bf16 v17, v14, v59
    v_dot2c_f32_bf16 v19, v59, v59
    s_waitcnt vmcnt(0)
    v_dot2c_f32_bf16 v16, v14, v60
    v_dot2c_f32_bf16 v18, v60, v60
    v_dot2c_f32_bf16 v17, v14, v61
    v_dot2c_f32_bf16 v19, v61, v61
    v_dot2c_f32_bf16 v16, v14, v62
    v_dot2c_f32_bf16 v18, v62, v62
    v_dot2c_f32_bf16 v17, v14, v63
    v_dot2c_f32_bf16 v19, v63, v63
    s_nop 2
    v_add_f32 v16, v16, v17
    v_add_f32 v18, v18, v19
    s_nop 0
    v_add_f32_dpp v16, v16, v16 quad_perm:[1,0,3,2] row_mask:0xf bank_mask:0xf
    v_add_f32_dpp v18, v18, v18 quad_perm:[1,0,3,2] row_mask:0xf bank_mask:0xf
    s_nop 0
    v_add_f32_dpp v16, v16, v16 quad_perm:[2,3,0,1] row_mask:0xf bank_mask:0xf
    v_add_f32_dpp v18, v18, v18 quad_perm:[2,3,0,1] row_mask:0xf bank_mask:0xf
    s_nop 0
    v_add_f32_dpp v16, v16, v16 row_half_mirror row_mask:0xf bank_mask:0xf
    v_add_f32_dpp v18, v18, v18 row_half_mirror row_mask:0xf bank_mask:0xf
    v_mul_f32 v16, 0x3b000000, v16
    v_mul_f32 v18, 0x3b000000, v18
    v_fma_f32 v18, -v16, v16, v18
    v_max_f32 v18, 0, v18
    v_cvt_pk_bf16_f32 v17, v16, v18
    v_lshlrev_b32 v16, 16, v17
    v_and_b32 v18, v15, v17
    v_add_f32 v18, 0x3727c5ac, v18
    v_cvt_pk_bf16_f32 v18, v18, v18
    v_and_b32 v18, v15, v18
    v_sqrt_f32 v18, v18
    s_nop 0
    v_cvt_pk_bf16_f32 v18, v18, v18
    v_and_b32 v18, v15, v18
    v_rcp_f32 v20, v18
    s_nop 0
    v_mul_f32 v21, -v16, v20
    v_lshlrev_b32 v64, 16, v32
    v_and_b32 v65, v15, v32
    v_lshlrev_b32 v66, 16, v33
    v_and_b32 v67, v15, v33
    v_lshlrev_b32 v68, 16, v34
    v_and_b32 v69, v15, v34
    v_lshlrev_b32 v70, 16, v35
    v_and_b32 v71, v15, v35
    v_pk_fma_f32 v[64:65], v[64:65], v[20:21], v[20:21] op_sel:[0,0,1] op_sel_hi:[1,0,1]
    v_pk_fma_f32 v[66:67], v[66:67], v[20:21], v[20:21] op_sel:[0,0,1] op_sel_hi:[1,0,1]
    v_pk_fma_f32 v[68:69], v[68:69], v[20:21], v[20:21] op_sel:[0,0,1] op_sel_hi:[1,0,1]
    v_pk_fma_f32 v[70:71], v[70:71], v[20:21], v[20:21] op_sel:[0,0,1] op_sel_hi:[1,0,1]
    v_cvt_pk_bf16_f32 v32, v64, v65
    v_cvt_pk_bf16_f32 v33, v66, v67
    v_cvt_pk_bf16_f32 v34, v68, v69
    v_cvt_pk_bf16_f32 v35, v70, v71
    ds_write_b128 v4, v[32:35] offset:0
    v_lshlrev_b32 v72, 16, v36
    v_and_b32 v73, v15, v36
    v_lshlrev_b32 v74, 16, v37
    v_and_b32 v75, v15, v37
    v_lshlrev_b32 v76, 16, v38
    v_and_b32 v77, v15, v38
    v_lshlrev_b32 v78, 16, v39
    v_and_b32 v79, v15, v39
    v_pk_fma_f32 v[72:73], v[72:73], v[20:21], v[20:21] op_sel:[0,0,1] op_sel_hi:[1,0,1]
    v_pk_fma_f32 v[74:75], v[74:75], v[20:21], v[20:21] op_sel:[0,0,1] op_sel_hi:[1,0,1]
    v_pk_fma_f32 v[76:77], v[76:77], v[20:21], v[20:21] op_sel:[0,0,1] op_sel_hi:[1,0,1]
    v_pk_fma_f32 v[78:79], v[78:79], v[20:21], v[20:21] op_sel:[0,0,1] op_sel_hi:[1,0,1]
    v_cvt_pk_bf16_f32 v36, v72, v73
    v_cvt_pk_bf16_f32 v37, v74, v75
    v_cvt_pk_bf16_f32 v38, v76, v77
    v_cvt_pk_bf16_f32 v39, v78, v79
    ds_write_b128 v4, v[36:39] offset:8192
    v_lshlrev_b32 v64, 16, v40
    v_and_b32 v65, v15, v40
    v_lshlrev_b32 v66, 16, v41
    v_and_b32 v67, v15, v41
    v_lshlrev_b32 v68, 16, v42
    v_and_b32 v69, v15, v42
    v_lshlrev_b32 v70, 16, v43
    v_and_b32 v71, v15, v43
    v_pk_fma_f32 v[64:65], v[64:65], v[20:21], v[20:21] op_sel:[0,0,1] op_sel_hi:[1,0,1]
    v_pk_fma_f32 v[66:67], v[66:67], v[20:21], v[20:21] op_sel:[0,0,1] op_sel_hi:[1,0,1]
    v_pk_fma_f32 v[68:69], v[68:69], v[20:21], v[20:21] op_sel:[0,0,1] op_sel_hi:[1,0,1]
    v_pk_fma_f32 v[70:71], v[70:71], v[20:21], v[20:21] op_sel:[0,0,1] op_sel_hi:[1,0,1]
    v_cvt_pk_bf16_f32 v40, v64, v65
    v_cvt_pk_bf16_f32 v41, v66, v67
    v_cvt_pk_bf16_f32 v42, v68, v69
    v_cvt_pk_bf16_f32 v43, v70, v71
    ds_write_b128 v4, v[40:43] offset:16384
    v_lshlrev_b32 v72, 16, v44
    v_and_b32 v73, v15, v44
    v_lshlrev_b32 v74, 16, v45
    v_and_b32 v75, v15, v45
    v_lshlrev_b32 v76, 16, v46
    v_and_b32 v77, v15, v46
    v_lshlrev_b32 v78, 16, v47
    v_and_b32 v79, v15, v47
    v_pk_fma_f32 v[72:73], v[72:73], v[20:21], v[20:21] op_sel:[0,0,1] op_sel_hi:[1,0,1]
    v_pk_fma_f32 v[74:75], v[74:75], v[20:21], v[20:21] op_sel:[0,0,1] op_sel_hi:[1,0,1]
    v_pk_fma_f32 v[76:77], v[76:77], v[20:21], v[20:21] op_sel:[0,0,1] op_sel_hi:[1,0,1]
    v_pk_fma_f32 v[78:79], v[78:79], v[20:21], v[20:21] op_sel:[0,0,1] op_sel_hi:[1,0,1]
    v_cvt_pk_bf16_f32 v44, v72, v73
    v_cvt_pk_bf16_f32 v45, v74, v75
    v_cvt_pk_bf16_f32 v46, v76, v77
    v_cvt_pk_bf16_f32 v47, v78, v79
    ds_write_b128 v4, v[44:47] offset:24576
    v_lshlrev_b32 v64, 16, v48
    v_and_b32 v65, v15, v48
    v_lshlrev_b32 v66, 16, v49
    v_and_b32 v67, v15, v49
    v_lshlrev_b32 v68, 16, v50
    v_and_b32 v69, v15, v50
    v_lshlrev_b32 v70, 16, v51
    v_and_b32 v71, v15, v51
    v_pk_fma_f32 v[64:65], v[64:65], v[20:21], v[20:21] op_sel:[0,0,1] op_sel_hi:[1,0,1]
    v_pk_fma_f32 v[66:67], v[66:67], v[20:21], v[20:21] op_sel:[0,0,1] op_sel_hi:[1,0,1]
    v_pk_fma_f32 v[68:69], v[68:69], v[20:21], v[20:21] op_sel:[0,0,1] op_sel_hi:[1,0,1]
    v_pk_fma_f32 v[70:71], v[70:71], v[20:21], v[20:21] op_sel:[0,0,1] op_sel_hi:[1,0,1]
    v_cvt_pk_bf16_f32 v48, v64, v65
    v_cvt_pk_bf16_f32 v49, v66, v67
    v_cvt_pk_bf16_f32 v50, v68, v69
    v_cvt_pk_bf16_f32 v51, v70, v71
    ds_write_b128 v4, v[48:51] offset:32768
    v_lshlrev_b32 v72, 16, v52
    v_and_b32 v73, v15, v52
    v_lshlrev_b32 v74, 16, v53
    v_and_b32 v75, v15, v53
    v_lshlrev_b32 v76, 16, v54
    v_and_b32 v77, v15, v54
    v_lshlrev_b32 v78, 16, v55
    v_and_b32 v79, v15, v55
    v_pk_fma_f32 v[72:73], v[72:73], v[20:21], v[20:21] op_sel:[0,0,1] op_sel_hi:[1,0,1]
    v_pk_fma_f32 v[74:75], v[74:75], v[20:21], v[20:21] op_sel:[0,0,1] op_sel_hi:[1,0,1]
    v_pk_fma_f32 v[76:77], v[76:77], v[20:21], v[20:21] op_sel:[0,0,1] op_sel_hi:[1,0,1]
    v_pk_fma_f32 v[78:79], v[78:79], v[20:21], v[20:21] op_sel:[0,0,1] op_sel_hi:[1,0,1]
    v_cvt_pk_bf16_f32 v52, v72, v73
    v_cvt_pk_bf16_f32 v53, v74, v75
    v_cvt_pk_bf16_f32 v54, v76, v77
    v_cvt_pk_bf16_f32 v55, v78, v79
    ds_write_b128 v4, v[52:55] offset:40960
    v_lshlrev_b32 v64, 16, v56
    v_and_b32 v65, v15, v56
    v_lshlrev_b32 v66, 16, v57
    v_and_b32 v67, v15, v57
    v_lshlrev_b32 v68, 16, v58
    v_and_b32 v69, v15, v58
    v_lshlrev_b32 v70, 16, v59
    v_and_b32 v71, v15, v59
    v_pk_fma_f32 v[64:65], v[64:65], v[20:21], v[20:21] op_sel:[0,0,1] op_sel_hi:[1,0,1]
    v_pk_fma_f32 v[66:67], v[66:67], v[20:21], v[20:21] op_sel:[0,0,1] op_sel_hi:[1,0,1]
    v_pk_fma_f32 v[68:69], v[68:69], v[20:21], v[20:21] op_sel:[0,0,1] op_sel_hi:[1,0,1]
    v_pk_fma_f32 v[70:71], v[70:71], v[20:21], v[20:21] op_sel:[0,0,1] op_sel_hi:[1,0,1]
    v_cvt_pk_bf16_f32 v56, v64, v65
    v_cvt_pk_bf16_f32 v57, v66, v67
    v_cvt_pk_bf16_f32 v58, v68, v69
    v_cvt_pk_bf16_f32 v59, v70, v71
    ds_write_b128 v4, v[56:59] offset:49152
    v_lshlrev_b32 v72, 16, v60
    v_and_b32 v73, v15, v60
    v_lshlrev_b32 v74, 16, v61
    v_and_b32 v75, v15, v61
    v_lshlrev_b32 v76, 16, v62
    v_and_b32 v77, v15, v62
    v_lshlrev_b32 v78, 16, v63
    v_and_b32 v79, v15, v63
    v_pk_fma_f32 v[72:73], v[72:73], v[20:21], v[20:21] op_sel:[0,0,1] op_sel_hi:[1,0,1]
    v_pk_fma_f32 v[74:75], v[74:75], v[20:21], v[20:21] op_sel:[0,0,1] op_sel_hi:[1,0,1]
    v_pk_fma_f32 v[76:77], v[76:77], v[20:21], v[20:21] op_sel:[0,0,1] op_sel_hi:[1,0,1]
    v_pk_fma_f32 v[78:79], v[78:79], v[20:21], v[20:21] op_sel:[0,0,1] op_sel_hi:[1,0,1]
    v_cvt_pk_bf16_f32 v60, v72, v73
    v_cvt_pk_bf16_f32 v61, v74, v75
    v_cvt_pk_bf16_f32 v62, v76, v77
    v_cvt_pk_bf16_f32 v63, v78, v79
    ds_write_b128 v4, v[60:63] offset:57344
    s_waitcnt lgkmcnt(0)
    s_mul_i32 s3, s3, 1664525
    s_add_u32 s3, s3, 1013904223
    s_cmp_lt_u32 s24, 4
    s_cbranch_scc1 L_ffn_7
    s_barrier
    s_setprio 3
    ds_read_b128 v[16:19], v5
    ds_read_b64_tr_b16 v[20:21], v9 offset:0
    ds_read_b64_tr_b16 v[22:23], v9 offset:512
    ds_read_b64_tr_b16 v[24:25], v9 offset:1024
    ds_read_b64_tr_b16 v[26:27], v9 offset:1536
    ds_read_b64_tr_b16 v[28:29], v9 offset:2048
    ds_read_b64_tr_b16 v[30:31], v9 offset:2560
    ds_read_b128 v[32:35], v6
    ds_read_b64_tr_b16 v[36:37], v9 offset:6144
    ds_read_b64_tr_b16 v[38:39], v9 offset:6656
    ds_read_b64_tr_b16 v[40:41], v9 offset:7168
    ds_read_b64_tr_b16 v[42:43], v9 offset:7680
    ds_read_b64_tr_b16 v[44:45], v9 offset:8192
    ds_read_b64_tr_b16 v[46:47], v9 offset:8704
    s_and_b32 s53, s56, 3
    s_waitcnt lgkmcnt(7)
    v_mfma_f32_32x32x16_bf16 v[80:95], v[20:23], v[16:19], 0
    ds_read_b128 v[48:51], v7
    ds_read_b64_tr_b16 v[52:53], v9 offset:12288
    ds_read_b64_tr_b16 v[54:55], v9 offset:12800
    s_cselect_b32 s54, s57, s59
    v_add_u32 v5, s58, v5
    v_mfma_f32_32x32x16_bf16 v[96:111], v[24:27], v[16:19], 0
    ds_read_b64_tr_b16 v[56:57], v9 offset:13312
    ds_read_b64_tr_b16 v[58:59], v9 offset:13824
    v_mfma_f32_32x32x16_bf16 v[112:127], v[16:19], v[28:31], 0
    ds_read_b64_tr_b16 v[60:61], v9 offset:14336
    ds_read_b64_tr_b16 v[62:63], v9 offset:14848
    s_branch L_gloop_8_1
.p2align 6
L_gloop_8:
    s_and_b32 s53, s56, 3
    s_waitcnt lgkmcnt(7)
    v_mfma_f32_32x32x16_bf16 v[80:95], v[20:23], v[16:19], v[80:95]
    ds_read_b128 v[48:51], v7
    ds_read_b64_tr_b16 v[52:53], v9 offset:12288
    ds_read_b64_tr_b16 v[54:55], v9 offset:12800
    s_cselect_b32 s54, s57, s59
    v_add_u32 v5, s58, v5
    v_mfma_f32_32x32x16_bf16 v[96:111], v[24:27], v[16:19], v[96:111]
    ds_read_b64_tr_b16 v[56:57], v9 offset:13312
    ds_read_b64_tr_b16 v[58:59], v9 offset:13824
    v_mfma_f32_32x32x16_bf16 v[112:127], v[16:19], v[28:31], v[112:127]
    ds_read_b64_tr_b16 v[60:61], v9 offset:14336
    ds_read_b64_tr_b16 v[62:63], v9 offset:14848
L_gloop_8_1:
    s_add_u32 s56, s56, 1
    s_waitcnt lgkmcnt(7)
    v_mfma_f32_32x32x16_bf16 v[80:95], v[36:39], v[32:35], v[80:95]
    ds_read_b128 v[64:67], v8
    ds_read_b64_tr_b16 v[68:69], v9 offset:18432
    ds_read_b64_tr_b16 v[70:71], v9 offset:18944
    v_add_u32 v6, s58, v6
    v_add_u32 v7, s58, v7
    v_mfma_f32_32x32x16_bf16 v[96:111], v[40:43], v[32:35], v[96:111]
    ds_read_b64_tr_b16 v[72:73], v9 offset:19456
    ds_read_b64_tr_b16 v[74:75], v9 offset:19968
    v_mfma_f32_32x32x16_bf16 v[112:127], v[32:35], v[44:47], v[112:127]
    ds_read_b64_tr_b16 v[76:77], v9 offset:20480
    ds_read_b64_tr_b16 v[78:79], v9 offset:20992
    v_add_u32 v8, s58, v8
    s_waitcnt lgkmcnt(7)
    v_mfma_f32_32x32x16_bf16 v[80:95], v[52:55], v[48:51], v[80:95]
    s_barrier
    v_add_u32 v9, s54, v9
    ds_read_b128 v[16:19], v5
    ds_read_b64_tr_b16 v[20:21], v9 offset:0
    ds_read_b64_tr_b16 v[22:23], v9 offset:512
    v_mfma_f32_32x32x16_bf16 v[96:111], v[56:59], v[48:51], v[96:111]
    ds_read_b64_tr_b16 v[24:25], v9 offset:1024
    ds_read_b64_tr_b16 v[26:27], v9 offset:1536
    v_mfma_f32_32x32x16_bf16 v[112:127], v[48:51], v[60:63], v[112:127]
    ds_read_b64_tr_b16 v[28:29], v9 offset:2048
    ds_read_b64_tr_b16 v[30:31], v9 offset:2560
    s_cmp_lg_u32 s56, 11
    s_waitcnt lgkmcnt(7)
    v_mfma_f32_32x32x16_bf16 v[80:95], v[68:71], v[64:67], v[80:95]
    ds_read_b128 v[32:35], v6
    ds_read_b64_tr_b16 v[36:37], v9 offset:6144
    ds_read_b64_tr_b16 v[38:39], v9 offset:6656
    v_mfma_f32_32x32x16_bf16 v[96:111], v[72:75], v[64:67], v[96:111]
    ds_read_b64_tr_b16 v[40:41], v9 offset:7168
    ds_read_b64_tr_b16 v[42:43], v9 offset:7680
    v_mfma_f32_32x32x16_bf16 v[112:127], v[64:67], v[76:79], v[112:127]
    ds_read_b64_tr_b16 v[44:45], v9 offset:8192
    ds_read_b64_tr_b16 v[46:47], v9 offset:8704
    s_cbranch_scc1 L_gloop_8
    s_nop 3
    v_mul_f32 v80, s52, v80
    v_mul_f32 v81, s52, v81
    v_mul_f32 v82, s52, v82
    v_mul_f32 v83, s52, v83
    v_mul_f32 v84, s52, v84
    v_mul_f32 v85, s52, v85
    v_mul_f32 v86, s52, v86
    v_mul_f32 v87, s52, v87
    v_mul_f32 v88, s52, v88
    v_mul_f32 v89, s52, v89
    v_mul_f32 v90, s52, v90
    v_mul_f32 v91, s52, v91
    v_mul_f32 v92, s52, v92
    v_mul_f32 v93, s52, v93
    v_mul_f32 v94, s52, v94
    v_mul_f32 v95, s52, v95
    v_cvt_pk_bf16_f32 v132, v80, v81
    v_cvt_pk_bf16_f32 v133, v82, v83
    v_cvt_pk_bf16_f32 v134, v84, v85
    v_cvt_pk_bf16_f32 v135, v86, v87
    v_cvt_pk_bf16_f32 v136, v88, v89
    v_cvt_pk_bf16_f32 v137, v90, v91
    v_cvt_pk_bf16_f32 v138, v92, v93
    v_cvt_pk_bf16_f32 v139, v94, v95
    buffer_store_dwordx4 v[132:135], v2, s[20:23], s48 offen sc0 sc1
    buffer_store_dwordx4 v[136:139], v2, s[20:23], s49 offen sc0 sc1
    v_cvt_pk_bf16_f32 v140, v96, v97
    v_cvt_pk_bf16_f32 v141, v98, v99
    v_cvt_pk_bf16_f32 v142, v100, v101
    v_cvt_pk_bf16_f32 v143, v102, v103
    v_cvt_pk_bf16_f32 v144, v104, v105
    v_cvt_pk_bf16_f32 v145, v106, v107
    v_cvt_pk_bf16_f32 v146, v108, v109
    v_cvt_pk_bf16_f32 v147, v110, v111
    v_cvt_pk_bf16_f32 v148, v112, v113
    v_cvt_pk_bf16_f32 v149, v114, v115
    v_cvt_pk_bf16_f32 v150, v116, v117
    v_cvt_pk_bf16_f32 v151, v118, v119
    v_cvt_pk_bf16_f32 v152, v120, v121
    v_cvt_pk_bf16_f32 v153, v122, v123
    v_cvt_pk_bf16_f32 v154, v124, v125
    v_cvt_pk_bf16_f32 v155, v126, v127
    s_nop 1
    v_permlane32_swap_b32 v148, v150
    v_permlane32_swap_b32 v149, v151
    v_permlane32_swap_b32 v152, v154
    v_permlane32_swap_b32 v153, v155
    v_mov_b32 v128, v2
    v_mov_b32 v129, v12
    s_mov_b32 s18, s50
    s_mov_b32 s19, s51
    buffer_store_dwordx4 v[140:143], v128, s[20:23], s18 offen sc0 sc1
    buffer_store_dwordx4 v[144:147], v128, s[20:23], s19 offen sc0 sc1
    buffer_store_dwordx4 v[148:151], v129, s[20:23], s18 offen offset:1024 sc0 sc1
    buffer_store_dwordx4 v[152:155], v129, s[20:23], s18 offen offset:1536 sc0 sc1
L_kvlate_9:
    s_setprio 0
L_attpre_3:
    s_waitcnt lgkmcnt(0)
    s_barrier
    s_lshl_b32 s29, s28, 3
    s_add_u32 s29, s29, s24
    s_sub_u32 s29, s29, 4
    v_lshlrev_b32 v10, 4, v1
    s_mov_b32 s40, 0x0000ffff
    s_mov_b32 s41, 0x0000ffff
    v_lshrrev_b32 v8, 5, v1
    v_lshlrev_b32 v11, 8, v8
    v_and_b32 v8, 15, v1
    v_lshl_add_u32 v11, v8, 4, v11
    v_add_u32 v11, 1024, v11
    v_mov_b32 v112, 0xdddd
    v_and_b32 v8, 27, v1
    v_cmp_eq_u32 vcc, 16, v8
    v_mov_b32 v8, 0x3f803f80
    s_nop 1
    v_cndmask_b32 v96, 0, v8, vcc
    v_mov_b32 v97, v96
    v_mov_b32 v98, v96
    v_mov_b32 v99, v96
    v_mov_b32 v100, v96
    v_mov_b32 v101, v96
    v_mov_b32 v102, v96
    v_mov_b32 v103, v96
    v_mov_b32 v104, v96
    v_mov_b32 v105, v96
    v_mov_b32 v106, v96
    v_mov_b32 v107, v96
    v_mov_b32 v108, v96
    v_mov_b32 v109, v96
    v_mov_b32 v110, v96
    v_mov_b32 v111, v96
    v_mov_b32 v72, 0
    v_mov_b32 v73, 0
    v_mov_b32 v74, 0
    v_mov_b32 v75, 0
    v_mov_b32 v76, 0
    v_mov_b32 v77, 0
    v_mov_b32 v78, 0
    v_mov_b32 v79, 0
    v_mov_b32 v80, 0
    v_mov_b32 v81, 0
    v_mov_b32 v82, 0
    v_mov_b32 v83, 0
    v_mov_b32 v84, 0
    v_mov_b32 v85, 0
    v_mov_b32 v86, 0
    v_mov_b32 v87, 0
    v_mov_b32 v56, 0
    v_mov_b32 v57, 0
    v_mov_b32 v58, 0
    v_mov_b32 v59, 0
    v_mov_b32 v60, 0
    v_mov_b32 v61, 0
    v_mov_b32 v62, 0
    v_mov_b32 v63, 0
    v_add_u32 v2, 2048, v10
    v_add_u32 v3, 2048, v11
    v_mov_b32 v12, 0
    v_mov_b32 v13, 1
    s_mov_b32 s44, 0
    s_mov_b32 s45, 2
    s_lshl_b32 s30, s27, 16
    s_lshl_b32 s35, s29, 10
    s_add_u32 s30, s30, s35
    s_add_u32 s30, s30, 0x0
    s_cmp_ge_u32 s24, 8
    s_cbranch_scc1 L_batch0_11
    s_lshl_b32 s31, s79, 5
    s_add_u32 s31, s31, s78
    s_lshl_b32 s31, s31, 7
    s_add_u32 s31, s31, 0x1420000
    s_waitcnt vmcnt(0)
    s_mov_b64 exec, 1
    ds_add_u32 v12, v13 offset:20
    s_mov_b64 exec, -1
    s_waitcnt vmcnt(0)
    s_mov_b64 exec, 1
    ds_add_rtn_u32 v16, v12, v13 offset:24
    v_mov_b32 v17, s3
    v_mov_b32 v18, 0
    s_waitcnt lgkmcnt(0)
    v_readfirstlane_b32 s42, v16
    s_nop 0
    s_cmp_lg_u32 s42, 3
    s_cbranch_scc1 L_nopub_13
    buffer_store_dword v17, v18, s[20:23], s31 offen sc0 sc1
L_nopub_13:
    s_mov_b64 exec, -1
    s_mov_b32 s47, 0
L_lw_14:
    ds_read_b32 v14, v12 offset:20
    s_waitcnt lgkmcnt(0)
    v_readfirstlane_b32 s46, v14
    s_add_u32 s47, s47, 1
    s_cmp_ge_u32 s46, 17
    s_cbranch_scc1 L_lw_14_d
    s_sleep 1
    s_cmp_lt_u32 s47, 0x2000000
    s_cbranch_scc1 L_lw_14
L_lw_14_d:
    buffer_load_dwordx4 v[4:7], v10, s[20:23], s30 offen sc0 sc1
    s_waitcnt vmcnt(0)
    s_branch L_takeq_12
L_batch0_11:
    s_and_b32 s32, s24, 3
    s_mul_i32 s32, s32, 6144
    s_lshl_b32 s31, s27, 17
    s_add_u32 s31, s31, s32
    s_add_u32 s31, s31, 0x200000
    s_add_u32 s33, s31, 3072
    v_add_u32 v9, s32, v2
    s_mov_b32 s47, 0
L_lw_15:
    ds_read_b32 v14, v12 offset:20
    s_waitcnt lgkmcnt(0)
    v_readfirstlane_b32 s46, v14
    s_add_u32 s47, s47, 1
    s_cmp_ge_u32 s46, 17
    s_cbranch_scc1 L_lw_15_d
    s_sleep 1
    s_cmp_lt_u32 s47, 0x2000000
    s_cbranch_scc1 L_lw_15
L_lw_15_d:
    s_add_u32 m0, s32, 2048
    s_nop 0
    buffer_load_dwordx4 v10, s[20:23], s31 offen offset:0 sc0 sc1 lds
    buffer_load_dwordx4 v10, s[20:23], s31 offen offset:1024 sc0 sc1 lds
    buffer_load_dwordx4 v10, s[20:23], s31 offen offset:2048 sc0 sc1 lds
    s_add_u32 m0, s32, 5120
    s_nop 0
    buffer_load_dwordx4 v10, s[20:23], s33 offen offset:0 sc0 sc1 lds
    buffer_load_dwordx4 v10, s[20:23], s33 offen offset:1024 sc0 sc1 lds
    buffer_load_dwordx4 v10, s[20:23], s33 offen offset:2048 sc0 sc1 lds
    buffer_load_dwordx4 v[4:7], v10, s[20:23], s30 offen sc0 sc1
    s_mov_b32 s42, 0
    s_waitcnt vmcnt(1)
    s_branch L_take_16_c
L_take_16:
    s_sleep 1
    s_add_u32 m0, s32, 2048
    s_nop 0
    buffer_load_dwordx4 v10, s[20:23], s31 offen offset:0 sc0 sc1 lds
    buffer_load_dwordx4 v10, s[20:23], s31 offen offset:1024 sc0 sc1 lds
    buffer_load_dwordx4 v10, s[20:23], s31 offen offset:2048 sc0 sc1 lds
    s_add_u32 m0, s32, 5120
    s_nop 0
    buffer_load_dwordx4 v10, s[20:23], s33 offen offset:0 sc0 sc1 lds
    buffer_load_dwordx4 v10, s[20:23], s33 offen offset:1024 sc0 sc1 lds
    buffer_load_dwordx4 v10, s[20:23], s33 offen offset:2048 sc0 sc1 lds
    s_waitcnt vmcnt(0)
L_take_16_c:
    ds_read_b128 v[32:35], v9 offset:0
    ds_read_b128 v[36:39], v9 offset:1024
    ds_read_b128 v[40:43], v9 offset:2048
    ds_read_b128 v[44:47], v9 offset:3072
    ds_read_b128 v[48:51], v9 offset:4096
    ds_read_b128 v[52:55], v9 offset:5120
    s_waitcnt lgkmcnt(0)
    v_max3_u32 v8, v32, v33, v34
    v_max3_u32 v8, v8, v35, v36
    v_max3_u32 v8, v8, v37, v38
    v_max3_u32 v8, v8, v39, v40
    v_max3_u32 v8, v8, v41, v42
    v_max3_u32 v8, v8, v43, v44
    v_max3_u32 v8, v8, v45, v46
    v_max3_u32 v8, v8, v47, v48
    v_max3_u32 v8, v8, v49, v50
    v_max3_u32 v8, v8, v51, v52
    v_max3_u32 v8, v8, v53, v54
    v_max_u32 v8, v8, v55
    v_cmp_eq_u32 vcc, -1, v8
    s_add_u32 s42, s42, 1
    s_nop 3
    s_cbranch_vccz L_take_16_d
    s_cmp_lt_u32 s42, 0x100000
    s_cbranch_scc1 L_take_16
L_take_16_d:
    s_mov_b64 exec, 1
    ds_add_u32 v12, v13 offset:32
    s_mov_b64 exec, -1
    s_waitcnt vmcnt(0)
L_takeq_12:
    s_mov_b32 s42, 0
    s_branch L_take_17_c
L_take_17:
    s_sleep 1
    buffer_load_dwordx4 v[4:7], v10, s[20:23], s30 offen sc0 sc1
    s_waitcnt vmcnt(0)
L_take_17_c:
    v_max3_u32 v8, v4, v5, v6
    v_max_u32 v8, v8, v7
    v_cmp_eq_u32 vcc, -1, v8
    s_add_u32 s42, s42, 1
    s_nop 3
    s_cbranch_vccz L_take_17_d
    s_cmp_lt_u32 s42, 0x100000
    s_cbranch_scc1 L_take_17
L_take_17_d:
    s_mov_b32 s47, 0
L_lw_18:
    ds_read_b32 v14, v12 offset:32
    s_waitcnt lgkmcnt(0)
    v_readfirstlane_b32 s46, v14
    s_add_u32 s47, s47, 1
    s_cmp_ge_u32 s46, 4
    s_cbranch_scc1 L_lw_18_d
    s_sleep 1
    s_cmp_lt_u32 s47, 0x2000000
    s_cbranch_scc1 L_lw_18
L_lw_18_d:
    s_setprio 3
    ds_read_b128 v[88:91], v2
    ds_read_b128 v[92:95], v2 offset:2048
    s_mov_b64 exec, s[40:41]
    ds_read_b128 v[96:99], v3
    ds_read_b128 v[100:103], v3 offset:512
    s_mov_b64 exec, -1
    s_waitcnt lgkmcnt(3)
    v_mfma_f32_32x32x16_bf16 v[32:47], v[88:91], v[4:7], 0
    s_nop 11
    v_max3_f32 v8, v32, v33, v34
    v_max3_f32 v8, v8, v35, v36
    v_max3_f32 v8, v8, v37, v38
    v_max3_f32 v8, v8, v39, v40
    v_max3_f32 v8, v8, v41, v42
    v_max3_f32 v8, v8, v43, v44
    v_max3_f32 v8, v8, v45, v46
    v_max_f32 v8, v8, v47
    v_mov_b32 v9, v8
    s_nop 1
    v_permlane32_swap_b32 v8, v9
    s_nop 1
    v_max_f32 v8, v8, v9
    v_sub_f32 v16, 0, v8
    v_mov_b32 v17, v16
    v_mov_b32 v18, v16
    v_mov_b32 v19, v16
    v_mov_b32 v20, v16
    v_mov_b32 v21, v16
    v_mov_b32 v22, v16
    v_mov_b32 v23, v16
    v_mov_b32 v24, v16
    v_mov_b32 v25, v16
    v_mov_b32 v26, v16
    v_mov_b32 v27, v16
    v_mov_b32 v28, v16
    v_mov_b32 v29, v16
    v_mov_b32 v30, v16
    v_mov_b32 v31, v16
    s_nop 1
    v_mfma_f32_32x32x16_bf16 v[32:47], v[88:91], v[4:7], v[16:31]
    s_nop 11
.p2align 6
L_attloop_10:
    ds_read_b128 v[88:91], v2 offset:4096
    v_exp_f32 v32, v32
    v_exp_f32 v33, v33
    v_smfmac_f32_32x32x32_bf16 v[72:87], v[108:111], v[56:63], v112
    v_exp_f32 v34, v34
    s_mov_b64 exec, s[40:41]
    ds_read_b128 v[104:107], v3 offset:2048
    ds_read_b128 v[108:111], v3 offset:2560
    s_mov_b64 exec, -1
    v_exp_f32 v35, v35
    v_exp_f32 v36, v36
    s_waitcnt lgkmcnt(3)
    v_mfma_f32_32x32x16_bf16 v[48:63], v[92:95], v[4:7], v[16:31]
    v_exp_f32 v37, v37
    v_exp_f32 v38, v38
    v_exp_f32 v39, v39
    v_exp_f32 v40, v40
    v_exp_f32_e64 v41, v41
    v_smfmac_f32_32x32x32_bf16 v[72:87], v[96:99], v[32:39], v112
    v_exp_f32 v42, v42
    v_exp_f32 v43, v43
    v_exp_f32 v44, v44
    v_exp_f32 v45, v45
    v_exp_f32 v46, v46
    v_exp_f32 v47, v47
    ds_read_b128 v[92:95], v2 offset:6144
    v_exp_f32 v48, v48
    v_exp_f32 v49, v49
    v_smfmac_f32_32x32x32_bf16 v[72:87], v[100:103], v[40:47], v112
    v_exp_f32 v50, v50
    s_mov_b64 exec, s[40:41]
    ds_read_b128 v[96:99], v3 offset:4096
    ds_read_b128 v[100:103], v3 offset:4608
    s_mov_b64 exec, -1
    v_exp_f32 v51, v51
    v_exp_f32 v52, v52
    s_waitcnt lgkmcnt(3)
    v_mfma_f32_32x32x16_bf16 v[32:47], v[88:91], v[4:7], v[16:31]
    v_exp_f32 v53, v53
    v_exp_f32 v54, v54
    v_exp_f32 v55, v55
    v_exp_f32 v56, v56
    v_exp_f32_e64 v57, v57
    v_smfmac_f32_32x32x32_bf16 v[72:87], v[104:107], v[48:55], v112
    v_exp_f32 v58, v58
    v_exp_f32 v59, v59
    v_exp_f32 v60, v60
    v_exp_f32 v61, v61
    v_exp_f32 v62, v62
    v_exp_f32 v63, v63
    ds_read_b128 v[88:91], v2 offset:8192
    v_exp_f32 v32, v32
    v_exp_f32 v33, v33
    v_smfmac_f32_32x32x32_bf16 v[72:87], v[108:111], v[56:63], v112
    v_exp_f32 v34, v34
    s_mov_b64 exec, s[40:41]
    ds_read_b128 v[104:107], v3 offset:6144
    ds_read_b128 v[108:111], v3 offset:6656
    s_mov_b64 exec, -1
    v_exp_f32 v35, v35
    v_exp_f32 v36, v36
    s_waitcnt lgkmcnt(3)
    v_mfma_f32_32x32x16_bf16 v[48:63], v[92:95], v[4:7], v[16:31]
    v_exp_f32 v37, v37
    v_exp_f32 v38, v38
    v_exp_f32 v39, v39
    v_exp_f32 v40, v40
    v_exp_f32_e64 v41, v41
    v_smfmac_f32_32x32x32_bf16 v[72:87], v[96:99], v[32:39], v112
    v_exp_f32 v42, v42
    v_exp_f32 v43, v43
    v_exp_f32 v44, v44
    v_exp_f32 v45, v45
    v_exp_f32 v46, v46
    v_exp_f32 v47, v47
    ds_read_b128 v[92:95], v2 offset:10240
    v_exp_f32 v48, v48
    v_exp_f32 v49, v49
    v_smfmac_f32_32x32x32_bf16 v[72:87], v[100:103], v[40:47], v112
    v_exp_f32 v50, v50
    s_mov_b64 exec, s[40:41]
    ds_read_b128 v[96:99], v3 offset:8192
    ds_read_b128 v[100:103], v3 offset:8704
    s_mov_b64 exec, -1
    v_exp_f32 v51, v51
    v_exp_f32 v52, v52
    s_waitcnt lgkmcnt(3)
    v_mfma_f32_32x32x16_bf16 v[32:47], v[88:91], v[4:7], v[16:31]
    v_exp_f32 v53, v53
    v_exp_f32 v54, v54
    v_exp_f32 v55, v55
    v_exp_f32 v56, v56
    v_exp_f32_e64 v57, v57
    v_smfmac_f32_32x32x32_bf16 v[72:87], v[104:107], v[48:55], v112
    v_exp_f32 v58, v58
    v_exp_f32 v59, v59
    v_exp_f32 v60, v60
    v_exp_f32 v61, v61
    v_exp_f32 v62, v62
    v_exp_f32 v63, v63
    v_add_u32 v2, 0x2000, v2
    v_add_u32 v3, 0x2000, v3
    s_add_u32 s44, s44, 1
    s_cmp_lg_u32 s44, s45
    s_cbranch_scc1 L_attloop_10
    s_cmp_lg_u32 s44, 16
    s_cbranch_scc1 L_attev_19
    s_setprio 3
    v_smfmac_f32_32x32x32_bf16 v[72:87], v[108:111], v[56:63], v112
    s_nop 2
    s_lshl_b32 s30, s29, 15
    s_lshl_b32 s31, s27, 10
    s_add_u32 s30, s30, s31
    s_add_u32 s30, s30, 0xe00000
    s_mov_b32 s45, 0x71800000
    s_nop 3
    s_mov_b32 s43, 0
L_attok_20:
    v_rcp_f32 v8, v80
    v_cmp_ngt_f32 s[46:47], s45, v80
    v_mul_f32 v72, v72, v8
    v_mul_f32 v73, v73, v8
    v_mul_f32 v74, v74, v8
    v_mul_f32 v75, v75, v8
    v_mul_f32 v76, v76, v8
    v_mul_f32 v77, v77, v8
    v_mul_f32 v78, v78, v8
    v_mul_f32 v79, v79, v8
    v_mul_f32 v8, 0, v72
    v_mul_f32 v9, 0, v73
    v_fma_f32 v8, v74, 0, v8
    v_fma_f32 v9, v75, 0, v9
    v_fma_f32 v8, v76, 0, v8
    v_fma_f32 v9, v77, 0, v9
    v_fma_f32 v8, v78, 0, v8
    v_fma_f32 v9, v79, 0, v9
    v_cmp_u_f32 vcc, v8, v9
    v_cvt_pk_bf16_f32 v64, v72, v73
    v_cvt_pk_bf16_f32 v65, v74, v75
    v_cvt_pk_bf16_f32 v66, v76, v77
    v_cvt_pk_bf16_f32 v67, v78, v79
    s_or_b64 s[46:47], s[46:47], vcc
    s_cbranch_scc1 L_attfb_21
L_attst_22:
    buffer_store_dwordx4 v[64:67], v10, s[20:23], s30 offen sc0 sc1
    s_mov_b64 exec, 1
    ds_add_u32 v12, v13 offset:40
    s_mov_b64 exec, -1
L_end_1:
    s_endpgm
L_attev_19:
    s_cmp_eq_u32 s44, 4
    s_cbranch_scc1 L_attev_19_4
    s_cmp_eq_u32 s44, 5
    s_cbranch_scc1 L_attev_19_5
    s_cmp_eq_u32 s44, 8
    s_cbranch_scc1 L_attev_19_8
    s_cmp_eq_u32 s44, 11
    s_cbranch_scc1 L_attev_19_11
    s_cmp_eq_u32 s44, 15
    s_cbranch_scc1 L_attev_19_15
L_attev_19_2:
    s_mov_b32 s47, 0
L_lw_23:
    ds_read_b32 v14, v12 offset:0
    s_waitcnt lgkmcnt(0)
    v_readfirstlane_b32 s46, v14
    s_add_u32 s47, s47, 1
    s_cmp_ge_u32 s46, 1
    s_cbranch_scc1 L_lw_23_d
    s_sleep 1
    s_cmp_lt_u32 s47, 0x2000000
    s_cbranch_scc1 L_lw_23
L_lw_23_d:
    s_mov_b32 s45, 4
    s_branch L_attloop_10
L_attev_19_4:
    s_setprio 2
    s_mov_b64 exec, 1
    ds_add_u32 v12, v13 offset:4
    s_mov_b64 exec, -1
    s_mov_b32 s45, 5
    s_branch L_attloop_10
L_attev_19_5:
    s_mov_b32 s47, 0
L_lw_24:
    ds_read_b32 v14, v12 offset:0
    s_waitcnt lgkmcnt(0)
    v_readfirstlane_b32 s46, v14
    s_add_u32 s47, s47, 1
    s_cmp_ge_u32 s46, 2
    s_cbranch_scc1 L_lw_24_d
    s_sleep 1
    s_cmp_lt_u32 s47, 0x2000000
    s_cbranch_scc1 L_lw_24
L_lw_24_d:
    s_mov_b32 s45, 8
    s_branch L_attloop_10
L_attev_19_8:
    s_mov_b64 exec, 1
    ds_add_u32 v12, v13 offset:36
    s_mov_b64 exec, -1
    s_mov_b32 s47, 0
L_lw_25:
    ds_read_b32 v14, v12 offset:0
    s_waitcnt lgkmcnt(0)
    v_readfirstlane_b32 s46, v14
    s_add_u32 s47, s47, 1
    s_cmp_ge_u32 s46, 3
    s_cbranch_scc1 L_lw_25_d
    s_sleep 1
    s_cmp_lt_u32 s47, 0x2000000
    s_cbranch_scc1 L_lw_25
L_lw_25_d:
    s_mov_b32 s45, 11
    s_branch L_attloop_10
L_attev_19_11:
    s_setprio 1
    s_mov_b32 s45, 15
    s_branch L_attloop_10
L_attev_19_15:
    s_setprio 0
    s_mov_b32 s45, 16
    s_branch L_attloop_10
L_attfb_21:
    s_cmp_lg_u32 s43, 0
    s_cbranch_scc1 L_attst_22
    s_mov_b32 s43, 1
    s_setprio 0
    s_waitcnt lgkmcnt(0)
    s_lshl_b32 s31, s27, 17
    s_add_u32 s31, s31, 0x200000
    s_mov_b32 s32, s31
    s_mov_b32 s44, 64
    v_mov_b32 v8, 0xff800000
L_attf1_26:
    buffer_load_dwordx4 v[88:91], v10, s[20:23], s32 offen sc0 sc1
    s_add_u32 s32, s32, 2048
    s_waitcnt vmcnt(0)
    v_mfma_f32_32x32x16_bf16 v[32:47], v[88:91], v[4:7], 0
    s_nop 11
    v_max3_f32 v8, v32, v33, v8
    v_max3_f32 v8, v8, v34, v35
    v_max3_f32 v8, v8, v36, v37
    v_max3_f32 v8, v8, v38, v39
    v_max3_f32 v8, v8, v40, v41
    v_max3_f32 v8, v8, v42, v43
    v_max3_f32 v8, v8, v44, v45
    v_max3_f32 v8, v8, v46, v47
    s_sub_u32 s44, s44, 1
    s_cmp_lg_u32 s44, 0
    s_cbranch_scc1 L_attf1_26
    v_mov_b32 v9, v8
    s_nop 1
    v_permlane32_swap_b32 v8, v9
    s_nop 1
    v_max_f32 v8, v8, v9
    v_sub_f32 v16, 0, v8
    v_mov_b32 v17, v16
    v_mov_b32 v18, v16
    v_mov_b32 v19, v16
    v_mov_b32 v20, v16
    v_mov_b32 v21, v16
    v_mov_b32 v22, v16
    v_mov_b32 v23, v16
    v_mov_b32 v24, v16
    v_mov_b32 v25, v16
    v_mov_b32 v26, v16
    v_mov_b32 v27, v16
    v_mov_b32 v28, v16
    v_mov_b32 v29, v16
    v_mov_b32 v30, v16
    v_mov_b32 v31, v16
    v_mov_b32 v72, 0
    v_mov_b32 v73, 0
    v_mov_b32 v74, 0
    v_mov_b32 v75, 0
    v_mov_b32 v76, 0
    v_mov_b32 v77, 0
    v_mov_b32 v78, 0
    v_mov_b32 v79, 0
    v_mov_b32 v80, 0
    v_mov_b32 v81, 0
    v_mov_b32 v82, 0
    v_mov_b32 v83, 0
    v_mov_b32 v84, 0
    v_mov_b32 v85, 0
    v_mov_b32 v86, 0
    v_mov_b32 v87, 0
    s_mov_b32 s32, s31
    s_mov_b32 s44, 64
L_attf2_27:
    buffer_load_dwordx4 v[88:91], v10, s[20:23], s32 offen sc0 sc1
    s_mov_b64 exec, s[40:41]
    buffer_load_dwordx4 v[96:99], v11, s[20:23], s32 offen sc0 sc1
    buffer_load_dwordx4 v[100:103], v11, s[20:23], s32 offen offset:512 sc0 sc1
    s_mov_b64 exec, -1
    s_add_u32 s32, s32, 2048
    s_waitcnt vmcnt(0)
    v_mfma_f32_32x32x16_bf16 v[32:47], v[88:91], v[4:7], v[16:31]
    s_nop 11
    v_exp_f32 v32, v32
    v_exp_f32 v33, v33
    v_exp_f32 v34, v34
    v_exp_f32 v35, v35
    v_exp_f32 v36, v36
    v_exp_f32 v37, v37
    v_exp_f32 v38, v38
    v_exp_f32 v39, v39
    v_exp_f32 v40, v40
    v_exp_f32 v41, v41
    v_exp_f32 v42, v42
    v_exp_f32 v43, v43
    v_exp_f32 v44, v44
    v_exp_f32 v45, v45
    v_exp_f32 v46, v46
    v_exp_f32 v47, v47
    s_nop 1
    v_smfmac_f32_32x32x32_bf16 v[72:87], v[96:99], v[32:39], v112
    v_smfmac_f32_32x32x32_bf16 v[72:87], v[100:103], v[40:47], v112
    s_sub_u32 s44, s44, 1
    s_cmp_lg_u32 s44, 0
    s_cbranch_scc1 L_attf2_27
    s_nop 11
    s_branch L_attok_20
L_ffn_7:
    s_mov_b32 s29, s24
    v_mov_b32 v10, 0
    v_mov_b32 v12, 1
    v_and_b32 v13, 31, v1
    v_lshrrev_b32 v14, 5, v1
    v_add_u32 v15, 0, v14
    v_xor_b32 v16, v13, v15
    v_lshlrev_b32 v16, 4, v16
    v_lshl_add_u32 v16, v15, 9, v16
    v_add_u32 v160, 98304, v16
    v_add_u32 v15, 2, v14
    v_xor_b32 v16, v13, v15
    v_lshlrev_b32 v16, 4, v16
    v_lshl_add_u32 v16, v15, 9, v16
    v_add_u32 v161, 98304, v16
    v_add_u32 v15, 4, v14
    v_xor_b32 v16, v13, v15
    v_lshlrev_b32 v16, 4, v16
    v_lshl_add_u32 v16, v15, 9, v16
    v_add_u32 v162, 98304, v16
    v_add_u32 v15, 6, v14
    v_xor_b32 v16, v13, v15
    v_lshlrev_b32 v16, 4, v16
    v_lshl_add_u32 v16, v15, 9, v16
    v_add_u32 v163, 98304, v16
    v_mov_b32 v16, -1
    v_mov_b32 v17, -1
    v_mov_b32 v18, -1
    v_mov_b32 v19, -1
    s_mov_b32 s16, s72
    s_mov_b32 s17, s73
    s_mov_b32 s18, 0x158000
    s_mov_b32 s19, 0x00020000
    s_mul_i32 s30, s29, 8192
    s_add_u32 s30, s30, 49152
    s_mul_i32 s39, s79, 3
    s_add_u32 s39, s39, s29
    s_lshl_b32 s33, s39, 7
    v_lshrrev_b32 v6, 3, v1
    v_and_b32 v7, 7, v1
    v_lshrrev_b32 v8, 2, v1
    v_and_b32 v8, 4, v8
    v_xor_b32 v7, v7, v8
    v_mul_u32_u24 v3, 2752, v6
    v_lshl_add_u32 v3, v7, 4, v3
    v_lshrrev_b32 v6, 5, v1
    v_lshlrev_b32 v4, 10, v6
    v_bfe_u32 v7, v1, 2, 2
    v_lshl_add_u32 v4, v7, 7, v4
    v_lshrrev_b32 v7, 1, v7
    v_lshl_add_u32 v4, v7, 6, v4
    v_bfe_u32 v7, v1, 4, 1
    v_lshl_add_u32 v4, v7, 5, v4
    v_and_b32 v7, 3, v1
    v_lshl_add_u32 v4, v7, 3, v4
    v_add_u32 v4, s30, v4
    v_xor_b32 v5, 64, v4
    s_lshr_b32 s38, s27, 2
    s_lshl_b32 s38, s38, 12
    s_add_u32 s38, s38, 0x1410000
    v_and_b32 v11, 31, v1
    v_lshlrev_b32 v11, 7, v11
    s_barrier
    s_lshl_b32 s34, s79, 2
    s_add_u32 s34, s34, s24
    s_lshl_b32 s35, s34, 16
    s_lshl_b32 s36, s78, 11
    s_add_u32 s36, s35, s36
    s_add_u32 s36, s36, 0x0
    buffer_store_dwordx4 v[16:19], v2, s[20:23], s36 offen offset:0 sc0 sc1
    buffer_store_dwordx4 v[16:19], v2, s[20:23], s36 offen offset:1024 sc0 sc1
    s_lshl_b32 s35, s35, 1
    s_lshl_b32 s36, s80, 12
    s_add_u32 s36, s36, s35
    s_add_u32 s36, s36, 0x200000
    s_barrier
    s_cmp_ge_u32 s80, 6
    s_cbranch_scc1 L_nokv_28
    buffer_store_dwordx4 v[16:19], v2, s[20:23], s36 offen offset:0 sc0 sc1
    buffer_store_dwordx4 v[16:19], v2, s[20:23], s36 offen offset:1024 sc0 sc1
L_nokv_28:
    s_barrier
    s_cmp_ge_u32 s80, 6
    s_cbranch_scc1 L_nokv_29
    buffer_store_dwordx4 v[16:19], v2, s[20:23], s36 offen offset:2048 sc0 sc1
    buffer_store_dwordx4 v[16:19], v2, s[20:23], s36 offen offset:3072 sc0 sc1
L_nokv_29:
    s_barrier
    s_barrier
    s_barrier
    s_waitcnt vmcnt(0)
    s_barrier
    s_cmp_eq_u32 s29, 3
    s_cbranch_scc1 L_pre6_30
    s_add_u32 s35, s55, 0
    s_and_b32 s35, s35, 7
    s_mul_i32 s35, s35, 176128
    s_add_u32 s35, s35, s33
    s_add_u32 m0, s30, 0
    s_add_u32 s34, s35, 0
    buffer_load_dwordx4 v3, s[16:19], s34 offen lds
    s_add_u32 m0, s30, 1024
    s_add_u32 s34, s35, 22016
    buffer_load_dwordx4 v3, s[16:19], s34 offen lds
    s_add_u32 m0, s30, 2048
    s_add_u32 s34, s35, 44032
    buffer_load_dwordx4 v3, s[16:19], s34 offen lds
    s_add_u32 m0, s30, 3072
    s_add_u32 s34, s35, 66048
    buffer_load_dwordx4 v3, s[16:19], s34 offen lds
    s_add_u32 m0, s30, 4096
    s_add_u32 s34, s35, 88064
    buffer_load_dwordx4 v3, s[16:19], s34 offen lds
    s_add_u32 m0, s30, 5120
    s_add_u32 s34, s35, 110080
    buffer_load_dwordx4 v3, s[16:19], s34 offen lds
    s_add_u32 m0, s30, 6144
    s_add_u32 s34, s35, 132096
    buffer_load_dwordx4 v3, s[16:19], s34 offen lds
    s_add_u32 m0, s30, 7168
    s_add_u32 s34, s35, 154112
    buffer_load_dwordx4 v3, s[16:19], s34 offen lds
L_pre6_30:
    s_cmp_lg_u32 s29, 3
    s_cbranch_scc1 L_noe_31
    s_lshl_b32 s36, s79, 5
    s_add_u32 s36, s36, s78
    s_lshl_b32 s36, s36, 7
    s_add_u32 s36, s36, 0x1410000
    v_mov_b32 v14, s3
    v_mov_b32 v15, 0
    s_mov_b64 exec, 1
    buffer_store_dword v14, v15, s[20:23], s36 offen sc0 sc1
    s_mov_b64 exec, -1
L_noe_31:
    s_barrier
    s_setprio 3
    s_cmp_eq_u32 s29, 3
    s_cbranch_scc1 L_aux3_32
    s_cmp_ge_u32 s39, 22
    s_cbranch_scc1 L_nof1_34
    s_barrier
    s_barrier
    s_add_u32 s35, s55, 1
    s_and_b32 s35, s35, 7
    s_mul_i32 s35, s35, 176128
    s_add_u32 s35, s35, s33
    s_add_u32 m0, s30, 24576
    s_add_u32 s34, s35, 0
    buffer_load_dwordx4 v3, s[16:19], s34 offen lds
    s_add_u32 m0, s30, 25600
    s_add_u32 s34, s35, 22016
    buffer_load_dwordx4 v3, s[16:19], s34 offen lds
    s_add_u32 m0, s30, 26624
    s_add_u32 s34, s35, 44032
    buffer_load_dwordx4 v3, s[16:19], s34 offen lds
    s_add_u32 m0, s30, 27648
    s_add_u32 s34, s35, 66048
    buffer_load_dwordx4 v3, s[16:19], s34 offen lds
    s_add_u32 m0, s30, 28672
    s_add_u32 s34, s35, 88064
    buffer_load_dwordx4 v3, s[16:19], s34 offen lds
    s_add_u32 m0, s30, 29696
    s_add_u32 s34, s35, 110080
    buffer_load_dwordx4 v3, s[16:19], s34 offen lds
    s_add_u32 m0, s30, 30720
    s_add_u32 s34, s35, 132096
    buffer_load_dwordx4 v3, s[16:19], s34 offen lds
    s_add_u32 m0, s30, 31744
    s_add_u32 s34, s35, 154112
    buffer_load_dwordx4 v3, s[16:19], s34 offen lds
    s_setprio 0
    s_waitcnt vmcnt(14)
    ds_read_b128 v[32:35], v160 offset:0
    ds_read_b64_tr_b16 v[16:17], v4 offset:0
    ds_read_b64_tr_b16 v[18:19], v4 offset:512
    ds_read_b128 v[36:39], v160 offset:4096
    ds_read_b64_tr_b16 v[20:21], v5 offset:0
    ds_read_b64_tr_b16 v[22:23], v5 offset:512
    s_waitcnt lgkmcnt(0)
    v_mfma_f32_32x32x16_bf16 v[96:111], v[16:19], v[32:35], 0
    s_waitcnt vmcnt(12)
    ds_read_b128 v[40:43], v161 offset:0
    ds_read_b64_tr_b16 v[24:25], v4 offset:2048
    ds_read_b64_tr_b16 v[26:27], v4 offset:2560
    v_mfma_f32_32x32x16_bf16 v[112:127], v[16:19], v[36:39], 0
    ds_read_b128 v[44:47], v161 offset:4096
    ds_read_b64_tr_b16 v[28:29], v5 offset:2048
    ds_read_b64_tr_b16 v[30:31], v5 offset:2560
    v_mfma_f32_32x32x16_bf16 v[128:143], v[20:23], v[32:35], 0
    s_add_u32 s35, s55, 2
    s_and_b32 s35, s35, 7
    s_mul_i32 s35, s35, 176128
    s_add_u32 s35, s35, s33
    s_add_u32 m0, s30, 0
    s_add_u32 s34, s35, 0
    buffer_load_dwordx4 v3, s[16:19], s34 offen lds
    v_mfma_f32_32x32x16_bf16 v[144:159], v[20:23], v[36:39], 0
    s_add_u32 m0, s30, 1024
    s_add_u32 s34, s35, 22016
    buffer_load_dwordx4 v3, s[16:19], s34 offen lds
    s_waitcnt lgkmcnt(0)
    v_mfma_f32_32x32x16_bf16 v[96:111], v[24:27], v[40:43], v[96:111]
    s_waitcnt vmcnt(12)
    ds_read_b128 v[32:35], v162 offset:0
    ds_read_b64_tr_b16 v[16:17], v4 offset:4096
    ds_read_b64_tr_b16 v[18:19], v4 offset:4608
    v_mfma_f32_32x32x16_bf16 v[112:127], v[24:27], v[44:47], v[112:127]
    ds_read_b128 v[36:39], v162 offset:4096
    ds_read_b64_tr_b16 v[20:21], v5 offset:4096
    ds_read_b64_tr_b16 v[22:23], v5 offset:4608
    v_mfma_f32_32x32x16_bf16 v[128:143], v[28:31], v[40:43], v[128:143]
    s_add_u32 m0, s30, 2048
    s_add_u32 s34, s35, 44032
    buffer_load_dwordx4 v3, s[16:19], s34 offen lds
    v_mfma_f32_32x32x16_bf16 v[144:159], v[28:31], v[44:47], v[144:159]
    s_add_u32 m0, s30, 3072
    s_add_u32 s34, s35, 66048
    buffer_load_dwordx4 v3, s[16:19], s34 offen lds
    s_waitcnt lgkmcnt(0)
    v_mfma_f32_32x32x16_bf16 v[96:111], v[16:19], v[32:35], v[96:111]
    s_waitcnt vmcnt(12)
    ds_read_b128 v[40:43], v163 offset:0
    ds_read_b64_tr_b16 v[24:25], v4 offset:6144
    ds_read_b64_tr_b16 v[26:27], v4 offset:6656
    v_mfma_f32_32x32x16_bf16 v[112:127], v[16:19], v[36:39], v[112:127]
    ds_read_b128 v[44:47], v163 offset:4096
    ds_read_b64_tr_b16 v[28:29], v5 offset:6144
    ds_read_b64_tr_b16 v[30:31], v5 offset:6656
    v_mfma_f32_32x32x16_bf16 v[128:143], v[20:23], v[32:35], v[128:143]
    s_add_u32 m0, s30, 4096
    s_add_u32 s34, s35, 88064
    buffer_load_dwordx4 v3, s[16:19], s34 offen lds
    v_mfma_f32_32x32x16_bf16 v[144:159], v[20:23], v[36:39], v[144:159]
    s_add_u32 m0, s30, 5120
    s_add_u32 s34, s35, 110080
    buffer_load_dwordx4 v3, s[16:19], s34 offen lds
    s_waitcnt lgkmcnt(0)
    v_mfma_f32_32x32x16_bf16 v[96:111], v[24:27], v[40:43], v[96:111]
    s_waitcnt vmcnt(12)
    ds_read_b128 v[32:35], v160 offset:8192
    ds_read_b64_tr_b16 v[16:17], v4 offset:24576
    ds_read_b64_tr_b16 v[18:19], v4 offset:25088
    v_mfma_f32_32x32x16_bf16 v[112:127], v[24:27], v[44:47], v[112:127]
    ds_read_b128 v[36:39], v160 offset:12288
    ds_read_b64_tr_b16 v[20:21], v5 offset:24576
    ds_read_b64_tr_b16 v[22:23], v5 offset:25088
    v_mfma_f32_32x32x16_bf16 v[128:143], v[28:31], v[40:43], v[128:143]
    s_add_u32 m0, s30, 6144
    s_add_u32 s34, s35, 132096
    buffer_load_dwordx4 v3, s[16:19], s34 offen lds
    v_mfma_f32_32x32x16_bf16 v[144:159], v[28:31], v[44:47], v[144:159]
    s_add_u32 m0, s30, 7168
    s_add_u32 s34, s35, 154112
    buffer_load_dwordx4 v3, s[16:19], s34 offen lds
    s_waitcnt lgkmcnt(0)
    v_mfma_f32_32x32x16_bf16 v[96:111], v[16:19], v[32:35], v[96:111]
    s_waitcnt vmcnt(12)
    ds_read_b128 v[40:43], v161 offset:8192
    ds_read_b64_tr_b16 v[24:25], v4 offset:26624
    ds_read_b64_tr_b16 v[26:27], v4 offset:27136
    v_mfma_f32_32x32x16_bf16 v[112:127], v[16:19], v[36:39], v[112:127]
    ds_read_b128 v[44:47], v161 offset:12288
    ds_read_b64_tr_b16 v[28:29], v5 offset:26624
    ds_read_b64_tr_b16 v[30:31], v5 offset:27136
    v_mfma_f32_32x32x16_bf16 v[128:143], v[20:23], v[32:35], v[128:143]
    s_add_u32 s35, s55, 3
    s_and_b32 s35, s35, 7
    s_mul_i32 s35, s35, 176128
    s_add_u32 s35, s35, s33
    s_add_u32 m0, s30, 24576
    s_add_u32 s34, s35, 0
    buffer_load_dwordx4 v3, s[16:19], s34 offen lds
    v_mfma_f32_32x32x16_bf16 v[144:159], v[20:23], v[36:39], v[144:159]
    s_add_u32 m0, s30, 25600
    s_add_u32 s34, s35, 22016
    buffer_load_dwordx4 v3, s[16:19], s34 offen lds
    s_waitcnt lgkmcnt(0)
    v_mfma_f32_32x32x16_bf16 v[96:111], v[24:27], v[40:43], v[96:111]
    s_waitcnt vmcnt(12)
    ds_read_b128 v[32:35], v162 offset:8192
    ds_read_b64_tr_b16 v[16:17], v4 offset:28672
    ds_read_b64_tr_b16 v[18:19], v4 offset:29184
    v_mfma_f32_32x32x16_bf16 v[112:127], v[24:27], v[44:47], v[112:127]
    ds_read_b128 v[36:39], v162 offset:12288
    ds_read_b64_tr_b16 v[20:21], v5 offset:28672
    ds_read_b64_tr_b16 v[22:23], v5 offset:29184
    v_mfma_f32_32x32x16_bf16 v[128:143], v[28:31], v[40:43], v[128:143]
    s_add_u32 m0, s30, 26624
    s_add_u32 s34, s35, 44032
    buffer_load_dwordx4 v3, s[16:19], s34 offen lds
    v_mfma_f32_32x32x16_bf16 v[144:159], v[28:31], v[44:47], v[144:159]
    s_add_u32 m0, s30, 27648
    s_add_u32 s34, s35, 66048
    buffer_load_dwordx4 v3, s[16:19], s34 offen lds
    s_waitcnt lgkmcnt(0)
    v_mfma_f32_32x32x16_bf16 v[96:111], v[16:19], v[32:35], v[96:111]
    s_waitcnt vmcnt(12)
    ds_read_b128 v[40:43], v163 offset:8192
    ds_read_b64_tr_b16 v[24:25], v4 offset:30720
    ds_read_b64_tr_b16 v[26:27], v4 offset:31232
    v_mfma_f32_32x32x16_bf16 v[112:127], v[16:19], v[36:39], v[112:127]
    ds_read_b128 v[44:47], v163 offset:12288
    ds_read_b64_tr_b16 v[28:29], v5 offset:30720
    ds_read_b64_tr_b16 v[30:31], v5 offset:31232
    v_mfma_f32_32x32x16_bf16 v[128:143], v[20:23], v[32:35], v[128:143]
    s_add_u32 m0, s30, 28672
    s_add_u32 s34, s35, 88064
    buffer_load_dwordx4 v3, s[16:19], s34 offen lds
    v_mfma_f32_32x32x16_bf16 v[144:159], v[20:23], v[36:39], v[144:159]
    s_add_u32 m0, s30, 29696
    s_add_u32 s34, s35, 110080
    buffer_load_dwordx4 v3, s[16:19], s34 offen lds
    s_waitcnt lgkmcnt(0)
    v_mfma_f32_32x32x16_bf16 v[96:111], v[24:27], v[40:43], v[96:111]
    s_waitcnt vmcnt(12)
    ds_read_b128 v[32:35], v160 offset:16384
    ds_read_b64_tr_b16 v[16:17], v4 offset:0
    ds_read_b64_tr_b16 v[18:19], v4 offset:512
    v_mfma_f32_32x32x16_bf16 v[112:127], v[24:27], v[44:47], v[112:127]
    ds_read_b128 v[36:39], v160 offset:20480
    ds_read_b64_tr_b16 v[20:21], v5 offset:0
    ds_read_b64_tr_b16 v[22:23], v5 offset:512
    v_mfma_f32_32x32x16_bf16 v[128:143], v[28:31], v[40:43], v[128:143]
    s_add_u32 m0, s30, 30720
    s_add_u32 s34, s35, 132096
    buffer_load_dwordx4 v3, s[16:19], s34 offen lds
    v_mfma_f32_32x32x16_bf16 v[144:159], v[28:31], v[44:47], v[144:159]
    s_add_u32 m0, s30, 31744
    s_add_u32 s34, s35, 154112
    buffer_load_dwordx4 v3, s[16:19], s34 offen lds
    s_waitcnt lgkmcnt(0)
    v_mfma_f32_32x32x16_bf16 v[96:111], v[16:19], v[32:35], v[96:111]
    s_waitcnt vmcnt(12)
    ds_read_b128 v[40:43], v161 offset:16384
    ds_read_b64_tr_b16 v[24:25], v4 offset:2048
    ds_read_b64_tr_b16 v[26:27], v4 offset:2560
    v_mfma_f32_32x32x16_bf16 v[112:127], v[16:19], v[36:39], v[112:127]
    ds_read_b128 v[44:47], v161 offset:20480
    ds_read_b64_tr_b16 v[28:29], v5 offset:2048
    ds_read_b64_tr_b16 v[30:31], v5 offset:2560
    v_mfma_f32_32x32x16_bf16 v[128:143], v[20:23], v[32:35], v[128:143]
    s_add_u32 s35, s55, 4
    s_and_b32 s35, s35, 7
    s_mul_i32 s35, s35, 176128
    s_add_u32 s35, s35, s33
    s_add_u32 m0, s30, 0
    s_add_u32 s34, s35, 0
    buffer_load_dwordx4 v3, s[16:19], s34 offen lds
    v_mfma_f32_32x32x16_bf16 v[144:159], v[20:23], v[36:39], v[144:159]
    s_add_u32 m0, s30, 1024
    s_add_u32 s34, s35, 22016
    buffer_load_dwordx4 v3, s[16:19], s34 offen lds
    s_waitcnt lgkmcnt(0)
    v_mfma_f32_32x32x16_bf16 v[96:111], v[24:27], v[40:43], v[96:111]
    s_waitcnt vmcnt(12)
    ds_read_b128 v[32:35], v162 offset:16384
    ds_read_b64_tr_b16 v[16:17], v4 offset:4096
    ds_read_b64_tr_b16 v[18:19], v4 offset:4608
    v_mfma_f32_32x32x16_bf16 v[112:127], v[24:27], v[44:47], v[112:127]
    ds_read_b128 v[36:39], v162 offset:20480
    ds_read_b64_tr_b16 v[20:21], v5 offset:4096
    ds_read_b64_tr_b16 v[22:23], v5 offset:4608
    v_mfma_f32_32x32x16_bf16 v[128:143], v[28:31], v[40:43], v[128:143]
    s_add_u32 m0, s30, 2048
    s_add_u32 s34, s35, 44032
    buffer_load_dwordx4 v3, s[16:19], s34 offen lds
    v_mfma_f32_32x32x16_bf16 v[144:159], v[28:31], v[44:47], v[144:159]
    s_add_u32 m0, s30, 3072
    s_add_u32 s34, s35, 66048
    buffer_load_dwordx4 v3, s[16:19], s34 offen lds
    s_waitcnt lgkmcnt(0)
    v_mfma_f32_32x32x16_bf16 v[96:111], v[16:19], v[32:35], v[96:111]
    s_waitcnt vmcnt(12)
    ds_read_b128 v[40:43], v163 offset:16384
    ds_read_b64_tr_b16 v[24:25], v4 offset:6144
    ds_read_b64_tr_b16 v[26:27], v4 offset:6656
    v_mfma_f32_32x32x16_bf16 v[112:127], v[16:19], v[36:39], v[112:127]
    ds_read_b128 v[44:47], v163 offset:20480
    ds_read_b64_tr_b16 v[28:29], v5 offset:6144
    ds_read_b64_tr_b16 v[30:31], v5 offset:6656
    v_mfma_f32_32x32x16_bf16 v[128:143], v[20:23], v[32:35], v[128:143]
    s_add_u32 m0, s30, 4096
    s_add_u32 s34, s35, 88064
    buffer_load_dwordx4 v3, s[16:19], s34 offen lds
    v_mfma_f32_32x32x16_bf16 v[144:159], v[20:23], v[36:39], v[144:159]
    s_add_u32 m0, s30, 5120
    s_add_u32 s34, s35, 110080
    buffer_load_dwordx4 v3, s[16:19], s34 offen lds
    s_waitcnt lgkmcnt(0)
    v_mfma_f32_32x32x16_bf16 v[96:111], v[24:27], v[40:43], v[96:111]
    s_waitcnt vmcnt(12)
    ds_read_b128 v[32:35], v160 offset:24576
    ds_read_b64_tr_b16 v[16:17], v4 offset:24576
    ds_read_b64_tr_b16 v[18:19], v4 offset:25088
    v_mfma_f32_32x32x16_bf16 v[112:127], v[24:27], v[44:47], v[112:127]
    ds_read_b128 v[36:39], v160 offset:28672
    ds_read_b64_tr_b16 v[20:21], v5 offset:24576
    ds_read_b64_tr_b16 v[22:23], v5 offset:25088
    v_mfma_f32_32x32x16_bf16 v[128:143], v[28:31], v[40:43], v[128:143]
    s_add_u32 m0, s30, 6144
    s_add_u32 s34, s35, 132096
    buffer_load_dwordx4 v3, s[16:19], s34 offen lds
    v_mfma_f32_32x32x16_bf16 v[144:159], v[28:31], v[44:47], v[144:159]
    s_add_u32 m0, s30, 7168
    s_add_u32 s34, s35, 154112
    buffer_load_dwordx4 v3, s[16:19], s34 offen lds
    s_waitcnt lgkmcnt(0)
    v_mfma_f32_32x32x16_bf16 v[96:111], v[16:19], v[32:35], v[96:111]
    s_waitcnt vmcnt(12)
    ds_read_b128 v[40:43], v161 offset:24576
    ds_read_b64_tr_b16 v[24:25], v4 offset:26624
    ds_read_b64_tr_b16 v[26:27], v4 offset:27136
    v_mfma_f32_32x32x16_bf16 v[112:127], v[16:19], v[36:39], v[112:127]
    ds_read_b128 v[44:47], v161 offset:28672
    ds_read_b64_tr_b16 v[28:29], v5 offset:26624
    ds_read_b64_tr_b16 v[30:31], v5 offset:27136
    v_mfma_f32_32x32x16_bf16 v[128:143], v[20:23], v[32:35], v[128:143]
    s_add_u32 s35, s55, 5
    s_and_b32 s35, s35, 7
    s_mul_i32 s35, s35, 176128
    s_add_u32 s35, s35, s33
    s_add_u32 m0, s30, 24576
    s_add_u32 s34, s35, 0
    buffer_load_dwordx4 v3, s[16:19], s34 offen lds
    v_mfma_f32_32x32x16_bf16 v[144:159], v[20:23], v[36:39], v[144:159]
    s_add_u32 m0, s30, 25600
    s_add_u32 s34, s35, 22016
    buffer_load_dwordx4 v3, s[16:19], s34 offen lds
    s_waitcnt lgkmcnt(0)
    v_mfma_f32_32x32x16_bf16 v[96:111], v[24:27], v[40:43], v[96:111]
    s_waitcnt vmcnt(12)
    ds_read_b128 v[32:35], v162 offset:24576
    ds_read_b64_tr_b16 v[16:17], v4 offset:28672
    ds_read_b64_tr_b16 v[18:19], v4 offset:29184
    v_mfma_f32_32x32x16_bf16 v[112:127], v[24:27], v[44:47], v[112:127]
    ds_read_b128 v[36:39], v162 offset:28672
    ds_read_b64_tr_b16 v[20:21], v5 offset:28672
    ds_read_b64_tr_b16 v[22:23], v5 offset:29184
    v_mfma_f32_32x32x16_bf16 v[128:143], v[28:31], v[40:43], v[128:143]
    s_add_u32 m0, s30, 26624
    s_add_u32 s34, s35, 44032
    buffer_load_dwordx4 v3, s[16:19], s34 offen lds
    v_mfma_f32_32x32x16_bf16 v[144:159], v[28:31], v[44:47], v[144:159]
    s_add_u32 m0, s30, 27648
    s_add_u32 s34, s35, 66048
    buffer_load_dwordx4 v3, s[16:19], s34 offen lds
    s_waitcnt lgkmcnt(0)
    v_mfma_f32_32x32x16_bf16 v[96:111], v[16:19], v[32:35], v[96:111]
    s_waitcnt vmcnt(12)
    ds_read_b128 v[40:43], v163 offset:24576
    ds_read_b64_tr_b16 v[24:25], v4 offset:30720
    ds_read_b64_tr_b16 v[26:27], v4 offset:31232
    v_mfma_f32_32x32x16_bf16 v[112:127], v[16:19], v[36:39], v[112:127]
    ds_read_b128 v[44:47], v163 offset:28672
    ds_read_b64_tr_b16 v[28:29], v5 offset:30720
    ds_read_b64_tr_b16 v[30:31], v5 offset:31232
    v_mfma_f32_32x32x16_bf16 v[128:143], v[20:23], v[32:35], v[128:143]
    s_add_u32 m0, s30, 28672
    s_add_u32 s34, s35, 88064
    buffer_load_dwordx4 v3, s[16:19], s34 offen lds
    v_mfma_f32_32x32x16_bf16 v[144:159], v[20:23], v[36:39], v[144:159]
    s_add_u32 m0, s30, 29696
    s_add_u32 s34, s35, 110080
    buffer_load_dwordx4 v3, s[16:19], s34 offen lds
    s_waitcnt lgkmcnt(0)
    v_mfma_f32_32x32x16_bf16 v[96:111], v[24:27], v[40:43], v[96:111]
    s_waitcnt vmcnt(12)
    ds_read_b128 v[32:35], v160 offset:32768
    ds_read_b64_tr_b16 v[16:17], v4 offset:0
    ds_read_b64_tr_b16 v[18:19], v4 offset:512
    v_mfma_f32_32x32x16_bf16 v[112:127], v[24:27], v[44:47], v[112:127]
    ds_read_b128 v[36:39], v160 offset:36864
    ds_read_b64_tr_b16 v[20:21], v5 offset:0
    ds_read_b64_tr_b16 v[22:23], v5 offset:512
    v_mfma_f32_32x32x16_bf16 v[128:143], v[28:31], v[40:43], v[128:143]
    s_add_u32 m0, s30, 30720
    s_add_u32 s34, s35, 132096
    buffer_load_dwordx4 v3, s[16:19], s34 offen lds
    v_mfma_f32_32x32x16_bf16 v[144:159], v[28:31], v[44:47], v[144:159]
    s_add_u32 m0, s30, 31744
    s_add_u32 s34, s35, 154112
    buffer_load_dwordx4 v3, s[16:19], s34 offen lds
    s_waitcnt lgkmcnt(0)
    v_mfma_f32_32x32x16_bf16 v[96:111], v[16:19], v[32:35], v[96:111]
    s_waitcnt vmcnt(12)
    ds_read_b128 v[40:43], v161 offset:32768
    ds_read_b64_tr_b16 v[24:25], v4 offset:2048
    ds_read_b64_tr_b16 v[26:27], v4 offset:2560
    v_mfma_f32_32x32x16_bf16 v[112:127], v[16:19], v[36:39], v[112:127]
    ds_read_b128 v[44:47], v161 offset:36864
    ds_read_b64_tr_b16 v[28:29], v5 offset:2048
    ds_read_b64_tr_b16 v[30:31], v5 offset:2560
    v_mfma_f32_32x32x16_bf16 v[128:143], v[20:23], v[32:35], v[128:143]
    s_add_u32 s35, s55, 6
    s_and_b32 s35, s35, 7
    s_mul_i32 s35, s35, 176128
    s_add_u32 s35, s35, s33
    s_add_u32 m0, s30, 0
    s_add_u32 s34, s35, 0
    buffer_load_dwordx4 v3, s[16:19], s34 offen lds
    v_mfma_f32_32x32x16_bf16 v[144:159], v[20:23], v[36:39], v[144:159]
    s_add_u32 m0, s30, 1024
    s_add_u32 s34, s35, 22016
    buffer_load_dwordx4 v3, s[16:19], s34 offen lds
    s_waitcnt lgkmcnt(0)
    v_mfma_f32_32x32x16_bf16 v[96:111], v[24:27], v[40:43], v[96:111]
    s_waitcnt vmcnt(12)
    ds_read_b128 v[32:35], v162 offset:32768
    ds_read_b64_tr_b16 v[16:17], v4 offset:4096
    ds_read_b64_tr_b16 v[18:19], v4 offset:4608
    v_mfma_f32_32x32x16_bf16 v[112:127], v[24:27], v[44:47], v[112:127]
    ds_read_b128 v[36:39], v162 offset:36864
    ds_read_b64_tr_b16 v[20:21], v5 offset:4096
    ds_read_b64_tr_b16 v[22:23], v5 offset:4608
    v_mfma_f32_32x32x16_bf16 v[128:143], v[28:31], v[40:43], v[128:143]
    s_add_u32 m0, s30, 2048
    s_add_u32 s34, s35, 44032
    buffer_load_dwordx4 v3, s[16:19], s34 offen lds
    v_mfma_f32_32x32x16_bf16 v[144:159], v[28:31], v[44:47], v[144:159]
    s_add_u32 m0, s30, 3072
    s_add_u32 s34, s35, 66048
    buffer_load_dwordx4 v3, s[16:19], s34 offen lds
    s_waitcnt lgkmcnt(0)
    v_mfma_f32_32x32x16_bf16 v[96:111], v[16:19], v[32:35], v[96:111]
    s_waitcnt vmcnt(12)
    ds_read_b128 v[40:43], v163 offset:32768
    ds_read_b64_tr_b16 v[24:25], v4 offset:6144
    ds_read_b64_tr_b16 v[26:27], v4 offset:6656
    v_mfma_f32_32x32x16_bf16 v[112:127], v[16:19], v[36:39], v[112:127]
    ds_read_b128 v[44:47], v163 offset:36864
    ds_read_b64_tr_b16 v[28:29], v5 offset:6144
    ds_read_b64_tr_b16 v[30:31], v5 offset:6656
    v_mfma_f32_32x32x16_bf16 v[128:143], v[20:23], v[32:35], v[128:143]
    s_add_u32 m0, s30, 4096
    s_add_u32 s34, s35, 88064
    buffer_load_dwordx4 v3, s[16:19], s34 offen lds
    v_mfma_f32_32x32x16_bf16 v[144:159], v[20:23], v[36:39], v[144:159]
    s_add_u32 m0, s30, 5120
    s_add_u32 s34, s35, 110080
    buffer_load_dwordx4 v3, s[16:19], s34 offen lds
    s_waitcnt lgkmcnt(0)
    v_mfma_f32_32x32x16_bf16 v[96:111], v[24:27], v[40:43], v[96:111]
    s_waitcnt vmcnt(12)
    ds_read_b128 v[32:35], v160 offset:40960
    ds_read_b64_tr_b16 v[16:17], v4 offset:24576
    ds_read_b64_tr_b16 v[18:19], v4 offset:25088
    v_mfma_f32_32x32x16_bf16 v[112:127], v[24:27], v[44:47], v[112:127]
    ds_read_b128 v[36:39], v160 offset:45056
    ds_read_b64_tr_b16 v[20:21], v5 offset:24576
    ds_read_b64_tr_b16 v[22:23], v5 offset:25088
    v_mfma_f32_32x32x16_bf16 v[128:143], v[28:31], v[40:43], v[128:143]
    s_add_u32 m0, s30, 6144
    s_add_u32 s34, s35, 132096
    buffer_load_dwordx4 v3, s[16:19], s34 offen lds
    v_mfma_f32_32x32x16_bf16 v[144:159], v[28:31], v[44:47], v[144:159]
    s_add_u32 m0, s30, 7168
    s_add_u32 s34, s35, 154112
    buffer_load_dwordx4 v3, s[16:19], s34 offen lds
    s_waitcnt lgkmcnt(0)
    v_mfma_f32_32x32x16_bf16 v[96:111], v[16:19], v[32:35], v[96:111]
    s_waitcnt vmcnt(12)
    ds_read_b128 v[40:43], v161 offset:40960
    ds_read_b64_tr_b16 v[24:25], v4 offset:26624
    ds_read_b64_tr_b16 v[26:27], v4 offset:27136
    v_mfma_f32_32x32x16_bf16 v[112:127], v[16:19], v[36:39], v[112:127]
    ds_read_b128 v[44:47], v161 offset:45056
    ds_read_b64_tr_b16 v[28:29], v5 offset:26624
    ds_read_b64_tr_b16 v[30:31], v5 offset:27136
    v_mfma_f32_32x32x16_bf16 v[128:143], v[20:23], v[32:35], v[128:143]
    s_add_u32 s35, s55, 7
    s_and_b32 s35, s35, 7
    s_mul_i32 s35, s35, 176128
    s_add_u32 s35, s35, s33
    s_add_u32 m0, s30, 24576
    s_add_u32 s34, s35, 0
    buffer_load_dwordx4 v3, s[16:19], s34 offen lds
    v_mfma_f32_32x32x16_bf16 v[144:159], v[20:23], v[36:39], v[144:159]
    s_add_u32 m0, s30, 25600
    s_add_u32 s34, s35, 22016
    buffer_load_dwordx4 v3, s[16:19], s34 offen lds
    s_waitcnt lgkmcnt(0)
    v_mfma_f32_32x32x16_bf16 v[96:111], v[24:27], v[40:43], v[96:111]
    s_waitcnt vmcnt(12)
    ds_read_b128 v[32:35], v162 offset:40960
    ds_read_b64_tr_b16 v[16:17], v4 offset:28672
    ds_read_b64_tr_b16 v[18:19], v4 offset:29184
    v_mfma_f32_32x32x16_bf16 v[112:127], v[24:27], v[44:47], v[112:127]
    ds_read_b128 v[36:39], v162 offset:45056
    ds_read_b64_tr_b16 v[20:21], v5 offset:28672
    ds_read_b64_tr_b16 v[22:23], v5 offset:29184
    v_mfma_f32_32x32x16_bf16 v[128:143], v[28:31], v[40:43], v[128:143]
    s_add_u32 m0, s30, 26624
    s_add_u32 s34, s35, 44032
    buffer_load_dwordx4 v3, s[16:19], s34 offen lds
    v_mfma_f32_32x32x16_bf16 v[144:159], v[28:31], v[44:47], v[144:159]
    s_add_u32 m0, s30, 27648
    s_add_u32 s34, s35, 66048
    buffer_load_dwordx4 v3, s[16:19], s34 offen lds
    s_waitcnt lgkmcnt(0)
    v_mfma_f32_32x32x16_bf16 v[96:111], v[16:19], v[32:35], v[96:111]
    s_waitcnt vmcnt(12)
    ds_read_b128 v[40:43], v163 offset:40960
    ds_read_b64_tr_b16 v[24:25], v4 offset:30720
    ds_read_b64_tr_b16 v[26:27], v4 offset:31232
    v_mfma_f32_32x32x16_bf16 v[112:127], v[16:19], v[36:39], v[112:127]
    ds_read_b128 v[44:47], v163 offset:45056
    ds_read_b64_tr_b16 v[28:29], v5 offset:30720
    ds_read_b64_tr_b16 v[30:31], v5 offset:31232
    v_mfma_f32_32x32x16_bf16 v[128:143], v[20:23], v[32:35], v[128:143]
    s_add_u32 m0, s30, 28672
    s_add_u32 s34, s35, 88064
    buffer_load_dwordx4 v3, s[16:19], s34 offen lds
    v_mfma_f32_32x32x16_bf16 v[144:159], v[20:23], v[36:39], v[144:159]
    s_add_u32 m0, s30, 29696
    s_add_u32 s34, s35, 110080
    buffer_load_dwordx4 v3, s[16:19], s34 offen lds
    s_waitcnt lgkmcnt(0)
    v_mfma_f32_32x32x16_bf16 v[96:111], v[24:27], v[40:43], v[96:111]
    s_waitcnt vmcnt(12)
    ds_read_b128 v[32:35], v160 offset:49152
    ds_read_b64_tr_b16 v[16:17], v4 offset:0
    ds_read_b64_tr_b16 v[18:19], v4 offset:512
    v_mfma_f32_32x32x16_bf16 v[112:127], v[24:27], v[44:47], v[112:127]
    ds_read_b128 v[36:39], v160 offset:53248
    ds_read_b64_tr_b16 v[20:21], v5 offset:0
    ds_read_b64_tr_b16 v[22:23], v5 offset:512
    v_mfma_f32_32x32x16_bf16 v[128:143], v[28:31], v[40:43], v[128:143]
    s_add_u32 m0, s30, 30720
    s_add_u32 s34, s35, 132096
    buffer_load_dwordx4 v3, s[16:19], s34 offen lds
    v_mfma_f32_32x32x16_bf16 v[144:159], v[28:31], v[44:47], v[144:159]
    s_add_u32 m0, s30, 31744
    s_add_u32 s34, s35, 154112
    buffer_load_dwordx4 v3, s[16:19], s34 offen lds
    s_waitcnt lgkmcnt(0)
    v_mfma_f32_32x32x16_bf16 v[96:111], v[16:19], v[32:35], v[96:111]
    s_waitcnt vmcnt(12)
    ds_read_b128 v[40:43], v161 offset:49152
    ds_read_b64_tr_b16 v[24:25], v4 offset:2048
    ds_read_b64_tr_b16 v[26:27], v4 offset:2560
    v_mfma_f32_32x32x16_bf16 v[112:127], v[16:19], v[36:39], v[112:127]
    ds_read_b128 v[44:47], v161 offset:53248
    ds_read_b64_tr_b16 v[28:29], v5 offset:2048
    ds_read_b64_tr_b16 v[30:31], v5 offset:2560
    v_mfma_f32_32x32x16_bf16 v[128:143], v[20:23], v[32:35], v[128:143]
    v_mfma_f32_32x32x16_bf16 v[144:159], v[20:23], v[36:39], v[144:159]
    s_waitcnt lgkmcnt(0)
    v_mfma_f32_32x32x16_bf16 v[96:111], v[24:27], v[40:43], v[96:111]
    s_waitcnt vmcnt(10)
    ds_read_b128 v[32:35], v162 offset:49152
    ds_read_b64_tr_b16 v[16:17], v4 offset:4096
    ds_read_b64_tr_b16 v[18:19], v4 offset:4608
    v_mfma_f32_32x32x16_bf16 v[112:127], v[24:27], v[44:47], v[112:127]
    ds_read_b128 v[36:39], v162 offset:53248
    ds_read_b64_tr_b16 v[20:21], v5 offset:4096
    ds_read_b64_tr_b16 v[22:23], v5 offset:4608
    v_mfma_f32_32x32x16_bf16 v[128:143], v[28:31], v[40:43], v[128:143]
    v_mfma_f32_32x32x16_bf16 v[144:159], v[28:31], v[44:47], v[144:159]
    s_waitcnt lgkmcnt(0)
    v_mfma_f32_32x32x16_bf16 v[96:111], v[16:19], v[32:35], v[96:111]
    s_waitcnt vmcnt(8)
    ds_read_b128 v[40:43], v163 offset:49152
    ds_read_b64_tr_b16 v[24:25], v4 offset:6144
    ds_read_b64_tr_b16 v[26:27], v4 offset:6656
    v_mfma_f32_32x32x16_bf16 v[112:127], v[16:19], v[36:39], v[112:127]
    ds_read_b128 v[44:47], v163 offset:53248
    ds_read_b64_tr_b16 v[28:29], v5 offset:6144
    ds_read_b64_tr_b16 v[30:31], v5 offset:6656
    v_mfma_f32_32x32x16_bf16 v[128:143], v[20:23], v[32:35], v[128:143]
    v_mfma_f32_32x32x16_bf16 v[144:159], v[20:23], v[36:39], v[144:159]
    s_waitcnt lgkmcnt(0)
    v_mfma_f32_32x32x16_bf16 v[96:111], v[24:27], v[40:43], v[96:111]
    s_waitcnt vmcnt(6)
    ds_read_b128 v[32:35], v160 offset:57344
    ds_read_b64_tr_b16 v[16:17], v4 offset:24576
    ds_read_b64_tr_b16 v[18:19], v4 offset:25088
    v_mfma_f32_32x32x16_bf16 v[112:127], v[24:27], v[44:47], v[112:127]
    ds_read_b128 v[36:39], v160 offset:61440
    ds_read_b64_tr_b16 v[20:21], v5 offset:24576
    ds_read_b64_tr_b16 v[22:23], v5 offset:25088
    v_mfma_f32_32x32x16_bf16 v[128:143], v[28:31], v[40:43], v[128:143]
    v_mfma_f32_32x32x16_bf16 v[144:159], v[28:31], v[44:47], v[144:159]
    s_waitcnt lgkmcnt(0)
    v_mfma_f32_32x32x16_bf16 v[96:111], v[16:19], v[32:35], v[96:111]
    s_waitcnt vmcnt(4)
    ds_read_b128 v[40:43], v161 offset:57344
    ds_read_b64_tr_b16 v[24:25], v4 offset:26624
    ds_read_b64_tr_b16 v[26:27], v4 offset:27136
    v_mfma_f32_32x32x16_bf16 v[112:127], v[16:19], v[36:39], v[112:127]
    ds_read_b128 v[44:47], v161 offset:61440
    ds_read_b64_tr_b16 v[28:29], v5 offset:26624
    ds_read_b64_tr_b16 v[30:31], v5 offset:27136
    v_mfma_f32_32x32x16_bf16 v[128:143], v[20:23], v[32:35], v[128:143]
    v_mfma_f32_32x32x16_bf16 v[144:159], v[20:23], v[36:39], v[144:159]
    s_waitcnt lgkmcnt(0)
    v_mfma_f32_32x32x16_bf16 v[96:111], v[24:27], v[40:43], v[96:111]
    s_waitcnt vmcnt(2)
    ds_read_b128 v[32:35], v162 offset:57344
    ds_read_b64_tr_b16 v[16:17], v4 offset:28672
    ds_read_b64_tr_b16 v[18:19], v4 offset:29184
    v_mfma_f32_32x32x16_bf16 v[112:127], v[24:27], v[44:47], v[112:127]
    ds_read_b128 v[36:39], v162 offset:61440
    ds_read_b64_tr_b16 v[20:21], v5 offset:28672
    ds_read_b64_tr_b16 v[22:23], v5 offset:29184
    v_mfma_f32_32x32x16_bf16 v[128:143], v[28:31], v[40:43], v[128:143]
    v_mfma_f32_32x32x16_bf16 v[144:159], v[28:31], v[44:47], v[144:159]
    s_waitcnt lgkmcnt(0)
    v_mfma_f32_32x32x16_bf16 v[96:111], v[16:19], v[32:35], v[96:111]
    s_waitcnt vmcnt(0)
    ds_read_b128 v[40:43], v163 offset:57344
    ds_read_b64_tr_b16 v[24:25], v4 offset:30720
    ds_read_b64_tr_b16 v[26:27], v4 offset:31232
    v_mfma_f32_32x32x16_bf16 v[112:127], v[16:19], v[36:39], v[112:127]
    ds_read_b128 v[44:47], v163 offset:61440
    ds_read_b64_tr_b16 v[28:29], v5 offset:30720
    ds_read_b64_tr_b16 v[30:31], v5 offset:31232
    v_mfma_f32_32x32x16_bf16 v[128:143], v[20:23], v[32:35], v[128:143]
    v_mfma_f32_32x32x16_bf16 v[144:159], v[20:23], v[36:39], v[144:159]
    s_waitcnt lgkmcnt(0)
    v_mfma_f32_32x32x16_bf16 v[96:111], v[24:27], v[40:43], v[96:111]
    v_mfma_f32_32x32x16_bf16 v[112:127], v[24:27], v[44:47], v[112:127]
    v_mfma_f32_32x32x16_bf16 v[128:143], v[28:31], v[40:43], v[128:143]
    v_mfma_f32_32x32x16_bf16 v[144:159], v[28:31], v[44:47], v[144:159]
    s_setprio 3
    s_mov_b64 exec, 1
    ds_add_u32 v10, v12 offset:28
    s_mov_b64 exec, -1
    s_mul_i32 s31, s78, 180224
    s_lshl_b32 s32, s39, 12
    s_add_u32 s31, s31, s32
    s_add_u32 s31, s31, 0x800000
    s_add_u32 s32, s31, 90112
    s_nop 4
    v_cvt_pk_bf16_f32 v32, v96, v97
    v_cvt_pk_bf16_f32 v33, v98, v99
    v_cvt_pk_bf16_f32 v34, v100, v101
    v_cvt_pk_bf16_f32 v35, v102, v103
    v_cvt_pk_bf16_f32 v36, v104, v105
    v_cvt_pk_bf16_f32 v37, v106, v107
    v_cvt_pk_bf16_f32 v38, v108, v109
    v_cvt_pk_bf16_f32 v39, v110, v111
    v_pk_max_i16 v32, v32, 0
    v_pk_max_i16 v33, v33, 0
    v_pk_max_i16 v34, v34, 0
    v_pk_max_i16 v35, v35, 0
    v_pk_max_i16 v36, v36, 0
    v_pk_max_i16 v37, v37, 0
    v_pk_max_i16 v38, v38, 0
    v_pk_max_i16 v39, v39, 0
    buffer_store_dwordx4 v[32:35], v2, s[20:23], s31 offen offset:0 sc0 sc1
    buffer_store_dwordx4 v[36:39], v2, s[20:23], s31 offen offset:1024 sc0 sc1
    v_cvt_pk_bf16_f32 v40, v112, v113
    v_cvt_pk_bf16_f32 v41, v114, v115
    v_cvt_pk_bf16_f32 v42, v116, v117
    v_cvt_pk_bf16_f32 v43, v118, v119
    v_cvt_pk_bf16_f32 v44, v120, v121
    v_cvt_pk_bf16_f32 v45, v122, v123
    v_cvt_pk_bf16_f32 v46, v124, v125
    v_cvt_pk_bf16_f32 v47, v126, v127
    v_pk_max_i16 v40, v40, 0
    v_pk_max_i16 v41, v41, 0
    v_pk_max_i16 v42, v42, 0
    v_pk_max_i16 v43, v43, 0
    v_pk_max_i16 v44, v44, 0
    v_pk_max_i16 v45, v45, 0
    v_pk_max_i16 v46, v46, 0
    v_pk_max_i16 v47, v47, 0
    buffer_store_dwordx4 v[40:43], v2, s[20:23], s32 offen offset:0 sc0 sc1
    buffer_store_dwordx4 v[44:47], v2, s[20:23], s32 offen offset:1024 sc0 sc1
    v_cvt_pk_bf16_f32 v48, v128, v129
    v_cvt_pk_bf16_f32 v49, v130, v131
    v_cvt_pk_bf16_f32 v50, v132, v133
    v_cvt_pk_bf16_f32 v51, v134, v135
    v_cvt_pk_bf16_f32 v52, v136, v137
    v_cvt_pk_bf16_f32 v53, v138, v139
    v_cvt_pk_bf16_f32 v54, v140, v141
    v_cvt_pk_bf16_f32 v55, v142, v143
    v_pk_max_i16 v48, v48, 0
    v_pk_max_i16 v49, v49, 0
    v_pk_max_i16 v50, v50, 0
    v_pk_max_i16 v51, v51, 0
    v_pk_max_i16 v52, v52, 0
    v_pk_max_i16 v53, v53, 0
    v_pk_max_i16 v54, v54, 0
    v_pk_max_i16 v55, v55, 0
    buffer_store_dwordx4 v[48:51], v2, s[20:23], s31 offen offset:2048 sc0 sc1
    buffer_store_dwordx4 v[52:55], v2, s[20:23], s31 offen offset:3072 sc0 sc1
    v_cvt_pk_bf16_f32 v56, v144, v145
    v_cvt_pk_bf16_f32 v57, v146, v147
    v_cvt_pk_bf16_f32 v58, v148, v149
    v_cvt_pk_bf16_f32 v59, v150, v151
    v_cvt_pk_bf16_f32 v60, v152, v153
    v_cvt_pk_bf16_f32 v61, v154, v155
    v_cvt_pk_bf16_f32 v62, v156, v157
    v_cvt_pk_bf16_f32 v63, v158, v159
    v_pk_max_i16 v56, v56, 0
    v_pk_max_i16 v57, v57, 0
    v_pk_max_i16 v58, v58, 0
    v_pk_max_i16 v59, v59, 0
    v_pk_max_i16 v60, v60, 0
    v_pk_max_i16 v61, v61, 0
    v_pk_max_i16 v62, v62, 0
    v_pk_max_i16 v63, v63, 0
    buffer_store_dwordx4 v[56:59], v2, s[20:23], s32 offen offset:2048 sc0 sc1
    buffer_store_dwordx4 v[60:63], v2, s[20:23], s32 offen offset:3072 sc0 sc1
    s_branch L_f1sig_35
L_nof1_34:
    s_barrier
    s_barrier
    s_waitcnt vmcnt(0)
    s_mov_b64 exec, 1
    ds_add_u32 v10, v12 offset:28
    s_mov_b64 exec, -1
L_f1sig_35:
    s_lshl_b32 s35, s78, 10
    s_lshl_b32 s36, s79, 7
    s_add_u32 s35, s35, s36
    s_add_u32 s35, s35, 0x1430000
    s_waitcnt vmcnt(0)
    s_mov_b64 exec, 1
    ds_add_rtn_u32 v13, v10, v12 offset:8
    v_mov_b32 v14, s3
    v_mov_b32 v15, 0
    s_waitcnt lgkmcnt(0)
    v_readfirstlane_b32 s42, v13
    s_nop 0
    s_cmp_lg_u32 s42, 3
    s_cbranch_scc1 L_nopub_36
    buffer_store_dword v14, v15, s[20:23], s35 offen sc0 sc1
L_nopub_36:
    s_mov_b64 exec, -1
    s_branch L_auxf2_33
L_aux3_32:
    v_mov_b32 v15, 0
    v_lshlrev_b32 v9, 2, v1
    s_barrier
    ds_write_b32 v9, v15 offset:0
    s_waitcnt lgkmcnt(0)
    s_barrier
    s_mov_b32 s42, 0
L_poll_37:
    buffer_load_dword v16, v11, s[20:23], s38 offen sc0 sc1
L_poll_37_w:
    s_add_u32 s42, s42, 1
    s_waitcnt vmcnt(0)
    v_xor_b32 v16, s3, v16
    v_cmp_ne_u32 vcc, 0, v16
    s_nop 4
    s_cbranch_vccz L_poll_37_d
    s_sleep 4
    s_cmp_lt_u32 s42, 0x100000
    s_cbranch_scc1 L_poll_37
L_poll_37_d:
    v_mov_b32 v13, 16
    s_mov_b64 exec, 1
    ds_add_u32 v10, v13 offset:20
    s_mov_b64 exec, -1
    s_lshr_b32 s36, s27, 2
    s_lshl_b32 s36, s36, 12
    s_add_u32 s36, s36, 0x1420000
    s_lshl_b32 s31, s27, 17
    s_add_u32 s31, s31, 0x1ff800
    s_mov_b32 s43, 0
L_lw_38:
    ds_read_b32 v13, v10 offset:32
    s_waitcnt lgkmcnt(0)
    v_readfirstlane_b32 s42, v13
    s_add_u32 s43, s43, 1
    s_cmp_ge_u32 s42, 4
    s_cbranch_scc1 L_lw_38_d
    s_sleep 2
    s_cmp_lt_u32 s43, 0x2000000
    s_cbranch_scc1 L_lw_38
L_lw_38_d:
    s_mov_b32 s42, 0
L_poll_39:
    buffer_load_dword v16, v11, s[20:23], s36 offen sc0 sc1
L_poll_39_w:
    s_add_u32 s42, s42, 1
    s_waitcnt vmcnt(0)
    v_xor_b32 v16, s3, v16
    v_cmp_ne_u32 vcc, 0, v16
    s_nop 4
    s_cbranch_vccz L_poll_39_d
    s_sleep 4
    s_cmp_lt_u32 s42, 0x100000
    s_cbranch_scc1 L_poll_39
L_poll_39_d:
    s_mov_b32 s32, 26624
L_kvl_40:
    s_mov_b32 m0, s32
    s_add_u32 s34, s32, s31
    s_add_u32 s32, s32, 4096
    buffer_load_dwordx4 v2, s[20:23], s34 offen offset:0 sc0 sc1 lds
    buffer_load_dwordx4 v2, s[20:23], s34 offen offset:1024 sc0 sc1 lds
    buffer_load_dwordx4 v2, s[20:23], s34 offen offset:2048 sc0 sc1 lds
    buffer_load_dwordx4 v2, s[20:23], s34 offen offset:3072 sc0 sc1 lds
    s_cmp_lg_u32 s32, 47104
    s_cbranch_scc1 L_kvl_40
    v_mov_b32 v13, 1
    s_waitcnt vmcnt(0)
    ds_write_b32 v10, v13
    v_mov_b32 v16, -1
    v_mov_b32 v17, -1
    v_mov_b32 v18, -1
    v_mov_b32 v19, -1
    s_lshl_b32 s34, s28, 18
    s_lshl_b32 s35, s27, 10
    s_add_u32 s34, s34, s35
    s_add_u32 s34, s34, 0xe00000
    buffer_store_dwordx4 v[16:19], v2, s[20:23], s34 offen sc0 sc1
    s_add_u32 s34, s34, 32768
    buffer_store_dwordx4 v[16:19], v2, s[20:23], s34 offen sc0 sc1
    s_add_u32 s34, s34, 32768
    buffer_store_dwordx4 v[16:19], v2, s[20:23], s34 offen sc0 sc1
    s_add_u32 s34, s34, 32768
    buffer_store_dwordx4 v[16:19], v2, s[20:23], s34 offen sc0 sc1
    s_add_u32 s34, s34, 32768
    buffer_store_dwordx4 v[16:19], v2, s[20:23], s34 offen sc0 sc1
    s_add_u32 s34, s34, 32768
    buffer_store_dwordx4 v[16:19], v2, s[20:23], s34 offen sc0 sc1
    s_add_u32 s34, s34, 32768
    buffer_store_dwordx4 v[16:19], v2, s[20:23], s34 offen sc0 sc1
    s_add_u32 s34, s34, 32768
    buffer_store_dwordx4 v[16:19], v2, s[20:23], s34 offen sc0 sc1
    s_add_u32 s34, s34, 32768
    s_lshl_b32 s35, s78, 10
    s_lshl_b32 s36, s79, 7
    s_add_u32 s35, s35, s36
    s_add_u32 s35, s35, 0x1430000
    s_waitcnt vmcnt(0)
    s_mov_b64 exec, 1
    ds_add_rtn_u32 v13, v10, v12 offset:8
    v_mov_b32 v14, s3
    v_mov_b32 v15, 0
    s_waitcnt lgkmcnt(0)
    v_readfirstlane_b32 s42, v13
    s_nop 0
    s_cmp_lg_u32 s42, 3
    s_cbranch_scc1 L_nopub_41
    buffer_store_dword v14, v15, s[20:23], s35 offen sc0 sc1
L_nopub_41:
    s_mov_b64 exec, -1
    s_mov_b32 s43, 0
L_lw_42:
    ds_read_b32 v13, v10 offset:28
    s_waitcnt lgkmcnt(0)
    v_readfirstlane_b32 s42, v13
    s_add_u32 s43, s43, 1
    s_cmp_ge_u32 s42, 3
    s_cbranch_scc1 L_lw_42_d
    s_sleep 4
    s_cmp_lt_u32 s43, 0x2000000
    s_cbranch_scc1 L_lw_42
L_lw_42_d:
L_kvl_43:
    s_mov_b32 m0, s32
    s_add_u32 s34, s32, s31
    s_add_u32 s32, s32, 4096
    buffer_load_dwordx4 v2, s[20:23], s34 offen offset:0 sc0 sc1 lds
    buffer_load_dwordx4 v2, s[20:23], s34 offen offset:1024 sc0 sc1 lds
    buffer_load_dwordx4 v2, s[20:23], s34 offen offset:2048 sc0 sc1 lds
    buffer_load_dwordx4 v2, s[20:23], s34 offen offset:3072 sc0 sc1 lds
    s_cmp_lg_u32 s32, 75776
    s_cbranch_scc1 L_kvl_43
    v_mov_b32 v13, 2
    s_waitcnt vmcnt(0)
    ds_write_b32 v10, v13
L_kvl_44:
    s_mov_b32 m0, s32
    s_add_u32 s34, s32, s31
    s_add_u32 s32, s32, 4096
    buffer_load_dwordx4 v2, s[20:23], s34 offen offset:0 sc0 sc1 lds
    buffer_load_dwordx4 v2, s[20:23], s34 offen offset:1024 sc0 sc1 lds
    buffer_load_dwordx4 v2, s[20:23], s34 offen offset:2048 sc0 sc1 lds
    buffer_load_dwordx4 v2, s[20:23], s34 offen offset:3072 sc0 sc1 lds
    s_cmp_lg_u32 s32, 133120
    s_cbranch_scc1 L_kvl_44
    v_mov_b32 v13, 3
    s_waitcnt vmcnt(0)
    ds_write_b32 v10, v13
L_auxf2_33:
    s_mov_b32 s16, s74
    s_mov_b32 s17, s75
    s_mov_b32 s18, 0x158000
    s_mov_b32 s19, 0x00020000
    s_mov_b32 s64, s76
    s_mov_b32 s65, s77
    s_mov_b32 s66, 0x80000
    s_mov_b32 s67, 0x00020000
    s_mov_b32 s68, s10
    s_mov_b32 s69, s11
    s_mov_b32 s70, 0x200000
    s_mov_b32 s71, 0x00020000
    s_mul_i32 s30, s47, 15360
    s_add_u32 s30, s30, 133120
    s_lshl_b32 s49, s47, 14
    s_add_u32 s49, s49, 2048
    s_cmp_eq_u32 s46, 0
    s_cselect_b32 s30, s49, s30
    v_lshrrev_b32 v6, 3, v1
    v_and_b32 v7, 7, v1
    v_lshrrev_b32 v8, 2, v1
    v_and_b32 v8, 4, v8
    v_xor_b32 v7, v7, v8
    v_mul_u32_u24 v3, 1024, v6
    v_lshl_add_u32 v3, v7, 4, v3
    v_lshrrev_b32 v6, 5, v1
    v_lshlrev_b32 v4, 9, v6
    v_bfe_u32 v7, v1, 2, 2
    v_lshl_add_u32 v4, v7, 7, v4
    v_lshrrev_b32 v7, 1, v7
    v_xor_b32 v7, s46, v7
    v_lshl_add_u32 v4, v7, 6, v4
    v_bfe_u32 v7, v1, 4, 1
    v_lshl_add_u32 v4, v7, 5, v4
    v_and_b32 v7, 3, v1
    v_lshl_add_u32 v4, v7, 3, v4
    v_add_u32 v4, s30, v4
    v_xor_b32 v5, 64, v4
    s_mul_i32 s33, s29, 360448
    s_lshl_b32 s34, s28, 7
    s_add_u32 s33, s33, s34
    s_mul_i32 s31, s27, 180224
    s_add_u32 s31, s31, 0x800000
    s_mul_i32 s32, s29, 22528
    s_add_u32 s31, s31, s32
    s_mul_i32 s38, s47, 90112
    s_add_u32 s31, s31, s38
    s_lshl_b32 s38, s38, 1
    s_sub_u32 s32, 90112, s38
    s_cmp_lg_u32 s29, 0
    s_cbranch_scc1 L_nopoll_45
    v_and_b32 v13, 7, v1
    v_lshlrev_b32 v13, 7, v13
    s_lshl_b32 s35, s27, 10
    s_add_u32 s35, s35, 0x1430000
    s_mov_b32 s42, 0
L_poll_46:
    buffer_load_dword v16, v13, s[20:23], s35 offen sc0 sc1
L_poll_46_w:
    s_add_u32 s42, s42, 1
    s_waitcnt vmcnt(0)
    v_xor_b32 v16, s3, v16
    v_cmp_ne_u32 vcc, 0, v16
    s_nop 4
    s_cbranch_vccz L_poll_46_d
    s_sleep 4
    s_cmp_lt_u32 s42, 0x100000
    s_cbranch_scc1 L_poll_46
L_poll_46_d:
    ds_write_b32 v10, v12 offset:12
L_nopoll_45:
    s_mov_b32 s43, 0
L_lw_47:
    ds_read_b32 v13, v10 offset:12
    s_waitcnt lgkmcnt(0)
    v_readfirstlane_b32 s42, v13
    s_add_u32 s43, s43, 1
    s_cmp_ge_u32 s42, 1
    s_cbranch_scc1 L_lw_47_d
    s_sleep 2
    s_cmp_lt_u32 s43, 0x2000000
    s_cbranch_scc1 L_lw_47
L_lw_47_d:
    s_add_u32 s36, s31, 0
    s_add_u32 s37, s36, s32
    buffer_load_dwordx4 v[32:35], v2, s[20:23], s36 offen offset:0 sc0 sc1
    buffer_load_dwordx4 v[36:39], v2, s[20:23], s37 offen offset:0 sc0 sc1
    buffer_load_dwordx4 v[40:43], v2, s[20:23], s36 offen offset:1024 sc0 sc1
    buffer_load_dwordx4 v[44:47], v2, s[20:23], s37 offen offset:1024 sc0 sc1
    buffer_load_dwordx4 v[48:51], v2, s[20:23], s36 offen offset:2048 sc0 sc1
    buffer_load_dwordx4 v[52:55], v2, s[20:23], s37 offen offset:2048 sc0 sc1
    buffer_load_dwordx4 v[56:59], v2, s[20:23], s36 offen offset:3072 sc0 sc1
    buffer_load_dwordx4 v[60:63], v2, s[20:23], s37 offen offset:3072 sc0 sc1
    s_add_u32 s36, s31, 4096
    s_add_u32 s37, s36, s32
    buffer_load_dwordx4 v[64:67], v2, s[20:23], s36 offen offset:0 sc0 sc1
    buffer_load_dwordx4 v[68:71], v2, s[20:23], s37 offen offset:0 sc0 sc1
    buffer_load_dwordx4 v[72:75], v2, s[20:23], s36 offen offset:1024 sc0 sc1
    buffer_load_dwordx4 v[76:79], v2, s[20:23], s37 offen offset:1024 sc0 sc1
    buffer_load_dwordx4 v[80:83], v2, s[20:23], s36 offen offset:2048 sc0 sc1
    buffer_load_dwordx4 v[84:87], v2, s[20:23], s37 offen offset:2048 sc0 sc1
    buffer_load_dwordx4 v[88:91], v2, s[20:23], s36 offen offset:3072 sc0 sc1
    buffer_load_dwordx4 v[92:95], v2, s[20:23], s37 offen offset:3072 sc0 sc1
    s_mov_b32 s43, 0
L_lw_48:
    ds_read_b32 v13, v10 offset:4
    s_waitcnt lgkmcnt(0)
    v_readfirstlane_b32 s42, v13
    s_add_u32 s43, s43, 1
    s_cmp_ge_u32 s42, 8
    s_cbranch_scc1 L_lw_48_d
    s_sleep 4
    s_cmp_lt_u32 s43, 0x2000000
    s_cbranch_scc1 L_lw_48
L_lw_48_d:
    s_mov_b32 s43, 0
L_lw_49:
    ds_read_b32 v13, v10 offset:28
    s_waitcnt lgkmcnt(0)
    v_readfirstlane_b32 s42, v13
    s_add_u32 s43, s43, 1
    s_cmp_ge_u32 s42, 3
    s_cbranch_scc1 L_lw_49_d
    s_sleep 2
    s_cmp_lt_u32 s43, 0x2000000
    s_cbranch_scc1 L_lw_49
L_lw_49_d:
    s_add_u32 s35, s33, 0
    s_add_u32 m0, s30, 0
    s_add_u32 s34, s35, 0
    buffer_load_dwordx4 v3, s[16:19], s34 offen lds
    s_add_u32 m0, s30, 1024
    s_add_u32 s34, s35, 8192
    buffer_load_dwordx4 v3, s[16:19], s34 offen lds
    s_add_u32 m0, s30, 2048
    s_add_u32 s34, s35, 16384
    buffer_load_dwordx4 v3, s[16:19], s34 offen lds
    s_add_u32 m0, s30, 3072
    s_add_u32 s34, s35, 24576
    buffer_load_dwordx4 v3, s[16:19], s34 offen lds
    s_add_u32 m0, s30, 4096
    s_add_u32 s34, s35, 32768
    buffer_load_dwordx4 v3, s[16:19], s34 offen lds
    s_add_u32 m0, s30, 5120
    s_add_u32 s34, s35, 40960
    buffer_load_dwordx4 v3, s[16:19], s34 offen lds
    s_add_u32 m0, s30, 6144
    s_add_u32 s34, s35, 49152
    buffer_load_dwordx4 v3, s[16:19], s34 offen lds
    s_add_u32 m0, s30, 7168
    s_add_u32 s34, s35, 57344
    buffer_load_dwordx4 v3, s[16:19], s34 offen lds
    s_add_u32 s35, s33, 65536
    s_add_u32 m0, s30, 8192
    s_add_u32 s34, s35, 0
    buffer_load_dwordx4 v3, s[16:19], s34 offen lds
    s_add_u32 m0, s30, 9216
    s_add_u32 s34, s35, 8192
    buffer_load_dwordx4 v3, s[16:19], s34 offen lds
    s_add_u32 m0, s30, 10240
    s_add_u32 s34, s35, 16384
    buffer_load_dwordx4 v3, s[16:19], s34 offen lds
    s_add_u32 m0, s30, 11264
    s_add_u32 s34, s35, 24576
    buffer_load_dwordx4 v3, s[16:19], s34 offen lds
    s_add_u32 m0, s30, 12288
    s_add_u32 s34, s35, 32768
    buffer_load_dwordx4 v3, s[16:19], s34 offen lds
    s_add_u32 m0, s30, 13312
    s_add_u32 s34, s35, 40960
    buffer_load_dwordx4 v3, s[16:19], s34 offen lds
    s_setprio 0
    s_waitcnt vmcnt(12)
    ds_read_b64_tr_b16 v[16:17], v4 offset:0
    ds_read_b64_tr_b16 v[18:19], v4 offset:1024
    ds_read_b64_tr_b16 v[20:21], v5 offset:0
    ds_read_b64_tr_b16 v[22:23], v5 offset:1024
    s_waitcnt lgkmcnt(0)
    v_mfma_f32_32x32x16_bf16 v[96:111], v[16:19], v[32:35], 0
    s_waitcnt vmcnt(10)
    ds_read_b64_tr_b16 v[24:25], v4 offset:2048
    ds_read_b64_tr_b16 v[26:27], v4 offset:3072
    v_mfma_f32_32x32x16_bf16 v[112:127], v[16:19], v[36:39], 0
    ds_read_b64_tr_b16 v[28:29], v5 offset:2048
    ds_read_b64_tr_b16 v[30:31], v5 offset:3072
    v_mfma_f32_32x32x16_bf16 v[128:143], v[20:23], v[32:35], 0
    s_add_u32 m0, s30, 0
    s_add_u32 s34, s35, 49152
    buffer_load_dwordx4 v3, s[16:19], s34 offen lds
    v_mfma_f32_32x32x16_bf16 v[144:159], v[20:23], v[36:39], 0
    s_add_u32 m0, s30, 1024
    s_add_u32 s34, s35, 57344
    buffer_load_dwordx4 v3, s[16:19], s34 offen lds
    s_waitcnt lgkmcnt(0)
    v_mfma_f32_32x32x16_bf16 v[96:111], v[24:27], v[40:43], v[96:111]
    s_waitcnt vmcnt(10)
    ds_read_b64_tr_b16 v[16:17], v4 offset:4096
    ds_read_b64_tr_b16 v[18:19], v4 offset:5120
    s_add_u32 s36, s31, 8192
    s_add_u32 s37, s36, s32
    buffer_load_dwordx4 v[32:35], v2, s[20:23], s36 offen offset:0 sc0 sc1
    v_mfma_f32_32x32x16_bf16 v[112:127], v[24:27], v[44:47], v[112:127]
    ds_read_b64_tr_b16 v[20:21], v5 offset:4096
    ds_read_b64_tr_b16 v[22:23], v5 offset:5120
    buffer_load_dwordx4 v[36:39], v2, s[20:23], s37 offen offset:0 sc0 sc1
    v_mfma_f32_32x32x16_bf16 v[128:143], v[28:31], v[40:43], v[128:143]
    s_add_u32 s35, s33, 131072
    s_add_u32 m0, s30, 2048
    s_add_u32 s34, s35, 0
    buffer_load_dwordx4 v3, s[16:19], s34 offen lds
    v_mfma_f32_32x32x16_bf16 v[144:159], v[28:31], v[44:47], v[144:159]
    s_add_u32 m0, s30, 3072
    s_add_u32 s34, s35, 8192
    buffer_load_dwordx4 v3, s[16:19], s34 offen lds
    s_waitcnt lgkmcnt(0)
    v_mfma_f32_32x32x16_bf16 v[96:111], v[16:19], v[48:51], v[96:111]
    s_waitcnt vmcnt(12)
    ds_read_b64_tr_b16 v[24:25], v4 offset:6144
    ds_read_b64_tr_b16 v[26:27], v4 offset:7168
    buffer_load_dwordx4 v[40:43], v2, s[20:23], s36 offen offset:1024 sc0 sc1
    v_mfma_f32_32x32x16_bf16 v[112:127], v[16:19], v[52:55], v[112:127]
    ds_read_b64_tr_b16 v[28:29], v5 offset:6144
    ds_read_b64_tr_b16 v[30:31], v5 offset:7168
    buffer_load_dwordx4 v[44:47], v2, s[20:23], s37 offen offset:1024 sc0 sc1
    v_mfma_f32_32x32x16_bf16 v[128:143], v[20:23], v[48:51], v[128:143]
    s_add_u32 m0, s30, 4096
    s_add_u32 s34, s35, 16384
    buffer_load_dwordx4 v3, s[16:19], s34 offen lds
    v_mfma_f32_32x32x16_bf16 v[144:159], v[20:23], v[52:55], v[144:159]
    s_add_u32 m0, s30, 5120
    s_add_u32 s34, s35, 24576
    buffer_load_dwordx4 v3, s[16:19], s34 offen lds
    s_waitcnt lgkmcnt(0)
    v_mfma_f32_32x32x16_bf16 v[96:111], v[24:27], v[56:59], v[96:111]
    s_waitcnt vmcnt(14)
    ds_read_b64_tr_b16 v[16:17], v4 offset:8192
    ds_read_b64_tr_b16 v[18:19], v4 offset:9216
    buffer_load_dwordx4 v[48:51], v2, s[20:23], s36 offen offset:2048 sc0 sc1
    v_mfma_f32_32x32x16_bf16 v[112:127], v[24:27], v[60:63], v[112:127]
    ds_read_b64_tr_b16 v[20:21], v5 offset:8192
    ds_read_b64_tr_b16 v[22:23], v5 offset:9216
    buffer_load_dwordx4 v[52:55], v2, s[20:23], s37 offen offset:2048 sc0 sc1
    v_mfma_f32_32x32x16_bf16 v[128:143], v[28:31], v[56:59], v[128:143]
    s_add_u32 m0, s30, 6144
    s_add_u32 s34, s35, 32768
    buffer_load_dwordx4 v3, s[16:19], s34 offen lds
    v_mfma_f32_32x32x16_bf16 v[144:159], v[28:31], v[60:63], v[144:159]
    s_add_u32 m0, s30, 7168
    s_add_u32 s34, s35, 40960
    buffer_load_dwordx4 v3, s[16:19], s34 offen lds
    s_waitcnt lgkmcnt(0)
    v_mfma_f32_32x32x16_bf16 v[96:111], v[16:19], v[64:67], v[96:111]
    s_waitcnt vmcnt(16)
    ds_read_b64_tr_b16 v[24:25], v4 offset:10240
    ds_read_b64_tr_b16 v[26:27], v4 offset:11264
    buffer_load_dwordx4 v[56:59], v2, s[20:23], s36 offen offset:3072 sc0 sc1
    v_mfma_f32_32x32x16_bf16 v[112:127], v[16:19], v[68:71], v[112:127]
    ds_read_b64_tr_b16 v[28:29], v5 offset:10240
    ds_read_b64_tr_b16 v[30:31], v5 offset:11264
    buffer_load_dwordx4 v[60:63], v2, s[20:23], s37 offen offset:3072 sc0 sc1
    v_mfma_f32_32x32x16_bf16 v[128:143], v[20:23], v[64:67], v[128:143]
    s_add_u32 m0, s30, 8192
    s_add_u32 s34, s35, 49152
    buffer_load_dwordx4 v3, s[16:19], s34 offen lds
    v_mfma_f32_32x32x16_bf16 v[144:159], v[20:23], v[68:71], v[144:159]
    s_add_u32 m0, s30, 9216
    s_add_u32 s34, s35, 57344
    buffer_load_dwordx4 v3, s[16:19], s34 offen lds
    s_waitcnt lgkmcnt(0)
    v_mfma_f32_32x32x16_bf16 v[96:111], v[24:27], v[72:75], v[96:111]
    s_waitcnt vmcnt(18)
    ds_read_b64_tr_b16 v[16:17], v4 offset:12288
    ds_read_b64_tr_b16 v[18:19], v4 offset:13312
    s_add_u32 s36, s31, 12288
    s_add_u32 s37, s36, s32
    buffer_load_dwordx4 v[64:67], v2, s[20:23], s36 offen offset:0 sc0 sc1
    v_mfma_f32_32x32x16_bf16 v[112:127], v[24:27], v[76:79], v[112:127]
    ds_read_b64_tr_b16 v[20:21], v5 offset:12288
    ds_read_b64_tr_b16 v[22:23], v5 offset:13312
    buffer_load_dwordx4 v[68:71], v2, s[20:23], s37 offen offset:0 sc0 sc1
    v_mfma_f32_32x32x16_bf16 v[128:143], v[28:31], v[72:75], v[128:143]
    s_add_u32 s35, s33, 196608
    s_add_u32 m0, s30, 10240
    s_add_u32 s34, s35, 0
    buffer_load_dwordx4 v3, s[16:19], s34 offen lds
    v_mfma_f32_32x32x16_bf16 v[144:159], v[28:31], v[76:79], v[144:159]
    s_add_u32 m0, s30, 11264
    s_add_u32 s34, s35, 8192
    buffer_load_dwordx4 v3, s[16:19], s34 offen lds
    s_waitcnt lgkmcnt(0)
    v_mfma_f32_32x32x16_bf16 v[96:111], v[16:19], v[80:83], v[96:111]
    s_waitcnt vmcnt(20)
    ds_read_b64_tr_b16 v[24:25], v4 offset:0
    ds_read_b64_tr_b16 v[26:27], v4 offset:1024
    buffer_load_dwordx4 v[72:75], v2, s[20:23], s36 offen offset:1024 sc0 sc1
    v_mfma_f32_32x32x16_bf16 v[112:127], v[16:19], v[84:87], v[112:127]
    ds_read_b64_tr_b16 v[28:29], v5 offset:0
    ds_read_b64_tr_b16 v[30:31], v5 offset:1024
    buffer_load_dwordx4 v[76:79], v2, s[20:23], s37 offen offset:1024 sc0 sc1
    v_mfma_f32_32x32x16_bf16 v[128:143], v[20:23], v[80:83], v[128:143]
    s_add_u32 m0, s30, 12288
    s_add_u32 s34, s35, 16384
    buffer_load_dwordx4 v3, s[16:19], s34 offen lds
    v_mfma_f32_32x32x16_bf16 v[144:159], v[20:23], v[84:87], v[144:159]
    s_add_u32 m0, s30, 13312
    s_add_u32 s34, s35, 24576
    buffer_load_dwordx4 v3, s[16:19], s34 offen lds
    s_waitcnt lgkmcnt(0)
    v_mfma_f32_32x32x16_bf16 v[96:111], v[24:27], v[88:91], v[96:111]
    s_waitcnt vmcnt(20)
    ds_read_b64_tr_b16 v[16:17], v4 offset:2048
    ds_read_b64_tr_b16 v[18:19], v4 offset:3072
    buffer_load_dwordx4 v[80:83], v2, s[20:23], s36 offen offset:2048 sc0 sc1
    v_mfma_f32_32x32x16_bf16 v[112:127], v[24:27], v[92:95], v[112:127]
    ds_read_b64_tr_b16 v[20:21], v5 offset:2048
    ds_read_b64_tr_b16 v[22:23], v5 offset:3072
    buffer_load_dwordx4 v[84:87], v2, s[20:23], s37 offen offset:2048 sc0 sc1
    v_mfma_f32_32x32x16_bf16 v[128:143], v[28:31], v[88:91], v[128:143]
    s_add_u32 m0, s30, 0
    s_add_u32 s34, s35, 32768
    buffer_load_dwordx4 v3, s[16:19], s34 offen lds
    v_mfma_f32_32x32x16_bf16 v[144:159], v[28:31], v[92:95], v[144:159]
    s_add_u32 m0, s30, 1024
    s_add_u32 s34, s35, 40960
    buffer_load_dwordx4 v3, s[16:19], s34 offen lds
    s_waitcnt lgkmcnt(0)
    v_mfma_f32_32x32x16_bf16 v[96:111], v[16:19], v[32:35], v[96:111]
    s_waitcnt vmcnt(20)
    ds_read_b64_tr_b16 v[24:25], v4 offset:4096
    ds_read_b64_tr_b16 v[26:27], v4 offset:5120
    buffer_load_dwordx4 v[88:91], v2, s[20:23], s36 offen offset:3072 sc0 sc1
    v_mfma_f32_32x32x16_bf16 v[112:127], v[16:19], v[36:39], v[112:127]
    ds_read_b64_tr_b16 v[28:29], v5 offset:4096
    ds_read_b64_tr_b16 v[30:31], v5 offset:5120
    buffer_load_dwordx4 v[92:95], v2, s[20:23], s37 offen offset:3072 sc0 sc1
    v_mfma_f32_32x32x16_bf16 v[128:143], v[20:23], v[32:35], v[128:143]
    s_add_u32 m0, s30, 2048
    s_add_u32 s34, s35, 49152
    buffer_load_dwordx4 v3, s[16:19], s34 offen lds
    v_mfma_f32_32x32x16_bf16 v[144:159], v[20:23], v[36:39], v[144:159]
    s_add_u32 m0, s30, 3072
    s_add_u32 s34, s35, 57344
    buffer_load_dwordx4 v3, s[16:19], s34 offen lds
    s_waitcnt lgkmcnt(0)
    v_mfma_f32_32x32x16_bf16 v[96:111], v[24:27], v[40:43], v[96:111]
    s_waitcnt vmcnt(20)
    ds_read_b64_tr_b16 v[16:17], v4 offset:6144
    ds_read_b64_tr_b16 v[18:19], v4 offset:7168
    s_add_u32 s36, s31, 16384
    s_add_u32 s37, s36, s32
    buffer_load_dwordx4 v[32:35], v2, s[20:23], s36 offen offset:0 sc0 sc1
    v_mfma_f32_32x32x16_bf16 v[112:127], v[24:27], v[44:47], v[112:127]
    ds_read_b64_tr_b16 v[20:21], v5 offset:6144
    ds_read_b64_tr_b16 v[22:23], v5 offset:7168
    buffer_load_dwordx4 v[36:39], v2, s[20:23], s37 offen offset:0 sc0 sc1
    v_mfma_f32_32x32x16_bf16 v[128:143], v[28:31], v[40:43], v[128:143]
    s_add_u32 s35, s33, 262144
    s_add_u32 m0, s30, 4096
    s_add_u32 s34, s35, 0
    buffer_load_dwordx4 v3, s[16:19], s34 offen lds
    v_mfma_f32_32x32x16_bf16 v[144:159], v[28:31], v[44:47], v[144:159]
    s_add_u32 m0, s30, 5120
    s_add_u32 s34, s35, 8192
    buffer_load_dwordx4 v3, s[16:19], s34 offen lds
    s_waitcnt lgkmcnt(0)
    v_mfma_f32_32x32x16_bf16 v[96:111], v[16:19], v[48:51], v[96:111]
    s_waitcnt vmcnt(20)
    ds_read_b64_tr_b16 v[24:25], v4 offset:8192
    ds_read_b64_tr_b16 v[26:27], v4 offset:9216
    buffer_load_dwordx4 v[40:43], v2, s[20:23], s36 offen offset:1024 sc0 sc1
    v_mfma_f32_32x32x16_bf16 v[112:127], v[16:19], v[52:55], v[112:127]
    ds_read_b64_tr_b16 v[28:29], v5 offset:8192
    ds_read_b64_tr_b16 v[30:31], v5 offset:9216
    buffer_load_dwordx4 v[44:47], v2, s[20:23], s37 offen offset:1024 sc0 sc1
    v_mfma_f32_32x32x16_bf16 v[128:143], v[20:23], v[48:51], v[128:143]
    s_add_u32 m0, s30, 6144
    s_add_u32 s34, s35, 16384
    buffer_load_dwordx4 v3, s[16:19], s34 offen lds
    v_mfma_f32_32x32x16_bf16 v[144:159], v[20:23], v[52:55], v[144:159]
    s_add_u32 m0, s30, 7168
    s_add_u32 s34, s35, 24576
    buffer_load_dwordx4 v3, s[16:19], s34 offen lds
    s_waitcnt lgkmcnt(0)
    v_mfma_f32_32x32x16_bf16 v[96:111], v[24:27], v[56:59], v[96:111]
    s_waitcnt vmcnt(20)
    ds_read_b64_tr_b16 v[16:17], v4 offset:10240
    ds_read_b64_tr_b16 v[18:19], v4 offset:11264
    buffer_load_dwordx4 v[48:51], v2, s[20:23], s36 offen offset:2048 sc0 sc1
    v_mfma_f32_32x32x16_bf16 v[112:127], v[24:27], v[60:63], v[112:127]
    ds_read_b64_tr_b16 v[20:21], v5 offset:10240
    ds_read_b64_tr_b16 v[22:23], v5 offset:11264
    buffer_load_dwordx4 v[52:55], v2, s[20:23], s37 offen offset:2048 sc0 sc1
    v_mfma_f32_32x32x16_bf16 v[128:143], v[28:31], v[56:59], v[128:143]
    s_add_u32 m0, s30, 8192
    s_add_u32 s34, s35, 32768
    buffer_load_dwordx4 v3, s[16:19], s34 offen lds
    v_mfma_f32_32x32x16_bf16 v[144:159], v[28:31], v[60:63], v[144:159]
    s_add_u32 m0, s30, 9216
    s_add_u32 s34, s35, 40960
    buffer_load_dwordx4 v3, s[16:19], s34 offen lds
    s_waitcnt lgkmcnt(0)
    v_mfma_f32_32x32x16_bf16 v[96:111], v[16:19], v[64:67], v[96:111]
    s_waitcnt vmcnt(20)
    ds_read_b64_tr_b16 v[24:25], v4 offset:12288
    ds_read_b64_tr_b16 v[26:27], v4 offset:13312
    buffer_load_dwordx4 v[56:59], v2, s[20:23], s36 offen offset:3072 sc0 sc1
    v_mfma_f32_32x32x16_bf16 v[112:127], v[16:19], v[68:71], v[112:127]
    ds_read_b64_tr_b16 v[28:29], v5 offset:12288
    ds_read_b64_tr_b16 v[30:31], v5 offset:13312
    buffer_load_dwordx4 v[60:63], v2, s[20:23], s37 offen offset:3072 sc0 sc1
    v_mfma_f32_32x32x16_bf16 v[128:143], v[20:23], v[64:67], v[128:143]
    s_add_u32 m0, s30, 10240
    s_add_u32 s34, s35, 49152
    buffer_load_dwordx4 v3, s[16:19], s34 offen lds
    v_mfma_f32_32x32x16_bf16 v[144:159], v[20:23], v[68:71], v[144:159]
    s_add_u32 m0, s30, 11264
    s_add_u32 s34, s35, 57344
    buffer_load_dwordx4 v3, s[16:19], s34 offen lds
    s_waitcnt lgkmcnt(0)
    v_mfma_f32_32x32x16_bf16 v[96:111], v[24:27], v[72:75], v[96:111]
    s_waitcnt vmcnt(20)
    ds_read_b64_tr_b16 v[16:17], v4 offset:0
    ds_read_b64_tr_b16 v[18:19], v4 offset:1024
    s_add_u32 s36, s31, 20480
    s_add_u32 s37, s36, s32
    buffer_load_dwordx4 v[64:67], v2, s[20:23], s36 offen offset:0 sc0 sc1
    v_mfma_f32_32x32x16_bf16 v[112:127], v[24:27], v[76:79], v[112:127]
    ds_read_b64_tr_b16 v[20:21], v5 offset:0
    ds_read_b64_tr_b16 v[22:23], v5 offset:1024
    buffer_load_dwordx4 v[68:71], v2, s[20:23], s37 offen offset:0 sc0 sc1
    v_mfma_f32_32x32x16_bf16 v[128:143], v[28:31], v[72:75], v[128:143]
    s_add_u32 s35, s33, 327680
    s_add_u32 m0, s30, 12288
    s_add_u32 s34, s35, 0
    buffer_load_dwordx4 v3, s[16:19], s34 offen lds
    v_mfma_f32_32x32x16_bf16 v[144:159], v[28:31], v[76:79], v[144:159]
    s_add_u32 m0, s30, 13312
    s_add_u32 s34, s35, 8192
    buffer_load_dwordx4 v3, s[16:19], s34 offen lds
    s_waitcnt lgkmcnt(0)
    v_mfma_f32_32x32x16_bf16 v[96:111], v[16:19], v[80:83], v[96:111]
    s_waitcnt vmcnt(20)
    ds_read_b64_tr_b16 v[24:25], v4 offset:2048
    ds_read_b64_tr_b16 v[26:27], v4 offset:3072
    buffer_load_dwordx4 v[72:75], v2, s[20:23], s36 offen offset:1024 sc0 sc1
    v_mfma_f32_32x32x16_bf16 v[112:127], v[16:19], v[84:87], v[112:127]
    ds_read_b64_tr_b16 v[28:29], v5 offset:2048
    ds_read_b64_tr_b16 v[30:31], v5 offset:3072
    buffer_load_dwordx4 v[76:79], v2, s[20:23], s37 offen offset:1024 sc0 sc1
    v_mfma_f32_32x32x16_bf16 v[128:143], v[20:23], v[80:83], v[128:143]
    s_add_u32 m0, s30, 0
    s_add_u32 s34, s35, 16384
    buffer_load_dwordx4 v3, s[16:19], s34 offen lds
    v_mfma_f32_32x32x16_bf16 v[144:159], v[20:23], v[84:87], v[144:159]
    s_add_u32 m0, s30, 1024
    s_add_u32 s34, s35, 24576
    buffer_load_dwordx4 v3, s[16:19], s34 offen lds
    s_waitcnt lgkmcnt(0)
    v_mfma_f32_32x32x16_bf16 v[96:111], v[24:27], v[88:91], v[96:111]
    s_waitcnt vmcnt(20)
    ds_read_b64_tr_b16 v[16:17], v4 offset:4096
    ds_read_b64_tr_b16 v[18:19], v4 offset:5120
    v_mfma_f32_32x32x16_bf16 v[112:127], v[24:27], v[92:95], v[112:127]
    ds_read_b64_tr_b16 v[20:21], v5 offset:4096
    ds_read_b64_tr_b16 v[22:23], v5 offset:5120
    v_mfma_f32_32x32x16_bf16 v[128:143], v[28:31], v[88:91], v[128:143]
    v_mfma_f32_32x32x16_bf16 v[144:159], v[28:31], v[92:95], v[144:159]
    s_waitcnt lgkmcnt(0)
    v_mfma_f32_32x32x16_bf16 v[96:111], v[16:19], v[32:35], v[96:111]
    s_waitcnt vmcnt(16)
    ds_read_b64_tr_b16 v[24:25], v4 offset:6144
    ds_read_b64_tr_b16 v[26:27], v4 offset:7168
    v_mfma_f32_32x32x16_bf16 v[112:127], v[16:19], v[36:39], v[112:127]
    ds_read_b64_tr_b16 v[28:29], v5 offset:6144
    ds_read_b64_tr_b16 v[30:31], v5 offset:7168
    v_mfma_f32_32x32x16_bf16 v[128:143], v[20:23], v[32:35], v[128:143]
    v_mfma_f32_32x32x16_bf16 v[144:159], v[20:23], v[36:39], v[144:159]
    s_waitcnt lgkmcnt(0)
    v_mfma_f32_32x32x16_bf16 v[96:111], v[24:27], v[40:43], v[96:111]
    s_waitcnt vmcnt(12)
    ds_read_b64_tr_b16 v[16:17], v4 offset:8192
    ds_read_b64_tr_b16 v[18:19], v4 offset:9216
    v_mfma_f32_32x32x16_bf16 v[112:127], v[24:27], v[44:47], v[112:127]
    ds_read_b64_tr_b16 v[20:21], v5 offset:8192
    ds_read_b64_tr_b16 v[22:23], v5 offset:9216
    v_mfma_f32_32x32x16_bf16 v[128:143], v[28:31], v[40:43], v[128:143]
    v_mfma_f32_32x32x16_bf16 v[144:159], v[28:31], v[44:47], v[144:159]
    s_waitcnt lgkmcnt(0)
    v_mfma_f32_32x32x16_bf16 v[96:111], v[16:19], v[48:51], v[96:111]
    s_waitcnt vmcnt(8)
    ds_read_b64_tr_b16 v[24:25], v4 offset:10240
    ds_read_b64_tr_b16 v[26:27], v4 offset:11264
    v_mfma_f32_32x32x16_bf16 v[112:127], v[16:19], v[52:55], v[112:127]
    ds_read_b64_tr_b16 v[28:29], v5 offset:10240
    ds_read_b64_tr_b16 v[30:31], v5 offset:11264
    v_mfma_f32_32x32x16_bf16 v[128:143], v[20:23], v[48:51], v[128:143]
    v_mfma_f32_32x32x16_bf16 v[144:159], v[20:23], v[52:55], v[144:159]
    s_waitcnt lgkmcnt(0)
    v_mfma_f32_32x32x16_bf16 v[96:111], v[24:27], v[56:59], v[96:111]
    s_waitcnt vmcnt(4)
    ds_read_b64_tr_b16 v[16:17], v4 offset:12288
    ds_read_b64_tr_b16 v[18:19], v4 offset:13312
    v_mfma_f32_32x32x16_bf16 v[112:127], v[24:27], v[60:63], v[112:127]
    ds_read_b64_tr_b16 v[20:21], v5 offset:12288
    ds_read_b64_tr_b16 v[22:23], v5 offset:13312
    v_mfma_f32_32x32x16_bf16 v[128:143], v[28:31], v[56:59], v[128:143]
    v_mfma_f32_32x32x16_bf16 v[144:159], v[28:31], v[60:63], v[144:159]
    s_waitcnt lgkmcnt(0)
    v_mfma_f32_32x32x16_bf16 v[96:111], v[16:19], v[64:67], v[96:111]
    s_waitcnt vmcnt(0)
    ds_read_b64_tr_b16 v[24:25], v4 offset:0
    ds_read_b64_tr_b16 v[26:27], v4 offset:1024
    v_mfma_f32_32x32x16_bf16 v[112:127], v[16:19], v[68:71], v[112:127]
    ds_read_b64_tr_b16 v[28:29], v5 offset:0
    ds_read_b64_tr_b16 v[30:31], v5 offset:1024
    v_mfma_f32_32x32x16_bf16 v[128:143], v[20:23], v[64:67], v[128:143]
    v_mfma_f32_32x32x16_bf16 v[144:159], v[20:23], v[68:71], v[144:159]
    s_waitcnt lgkmcnt(0)
    v_mfma_f32_32x32x16_bf16 v[96:111], v[24:27], v[72:75], v[96:111]
    v_mfma_f32_32x32x16_bf16 v[112:127], v[24:27], v[76:79], v[112:127]
    v_mfma_f32_32x32x16_bf16 v[128:143], v[28:31], v[72:75], v[128:143]
    v_mfma_f32_32x32x16_bf16 v[144:159], v[28:31], v[76:79], v[144:159]
    s_setprio 3
    s_mov_b64 exec, 1
    ds_add_u32 v10, v12 offset:48
    s_mov_b64 exec, -1
    s_lshl_b32 s48, s29, 14
    s_add_u32 s48, s48, 2048
    s_lshl_b32 s49, s46, 15
    s_add_u32 s49, s49, 2048
    s_sub_u32 s49, s49, s30
    v_add_u32 v4, s49, v4
    v_add_u32 v5, s49, v5
    s_lshl_b32 s33, s29, 17
    s_lshl_b32 s34, s28, 7
    s_add_u32 s33, s33, s34
    s_lshl_b32 s31, s27, 16
    s_lshl_b32 s32, s46, 14
    s_add_u32 s31, s31, s32
    s_add_u32 s31, s31, 0xe00000
    s_lshl_b32 s38, s47, 15
    s_add_u32 s31, s31, s38
    v_and_b32 v6, 31, v1
    v_lshrrev_b32 v7, 5, v1
    v_lshlrev_b32 v11, 10, v6
    v_lshl_add_u32 v11, v7, 4, v11
    s_lshl_b32 s45, s27, 16
    s_add_u32 s45, s45, s38
    s_add_u32 s45, s45, s34
    s_lshl_b32 s44, s46, 6
    s_add_u32 s45, s45, s44
    buffer_load_dwordx4 v[24:27], v11, s[60:63], s45 offen
    buffer_load_dwordx4 v[28:31], v11, s[60:63], s45 offen offset:32
    s_mov_b32 s41, 0xffff0000
    s_xor_b32 s49, s29, 0
    s_mul_i32 s49, s49, 12288
    s_add_u32 s49, s49, 63488
    v_add_u32 v6, s49, v2
    s_xor_b32 s49, s29, 1
    s_mul_i32 s49, s49, 12288
    s_add_u32 s49, s49, 63488
    v_add_u32 v7, s49, v2
    s_xor_b32 s49, s29, 2
    s_mul_i32 s49, s49, 12288
    s_add_u32 s49, s49, 63488
    v_add_u32 v8, s49, v2
    s_xor_b32 s49, s29, 3
    s_mul_i32 s49, s49, 12288
    s_add_u32 s49, s49, 63488
    v_add_u32 v9, s49, v2
    s_mov_b32 s43, 0
L_lw_50:
    ds_read_b32 v13, v10 offset:48
    s_waitcnt lgkmcnt(0)
    v_readfirstlane_b32 s42, v13
    s_add_u32 s43, s43, 1
    s_cmp_ge_u32 s42, 4
    s_cbranch_scc1 L_lw_50_d
    s_sleep 1
    s_cmp_lt_u32 s43, 0x2000000
    s_cbranch_scc1 L_lw_50
L_lw_50_d:
    s_mov_b32 s43, 0
L_lw_51:
    ds_read_b32 v13, v10 offset:36
    s_waitcnt lgkmcnt(0)
    v_readfirstlane_b32 s42, v13
    s_add_u32 s43, s43, 1
    s_cmp_ge_u32 s42, 8
    s_cbranch_scc1 L_lw_51_d
    s_sleep 8
    s_cmp_lt_u32 s43, 0x2000000
    s_cbranch_scc1 L_lw_51
L_lw_51_d:
    s_add_u32 s35, s33, 0
    s_add_u32 m0, s48, 0
    s_add_u32 s34, s35, 0
    buffer_load_dwordx4 v3, s[64:67], s34 offen lds
    s_add_u32 m0, s48, 1024
    s_add_u32 s34, s35, 8192
    buffer_load_dwordx4 v3, s[64:67], s34 offen lds
    s_add_u32 m0, s48, 2048
    s_add_u32 s34, s35, 16384
    buffer_load_dwordx4 v3, s[64:67], s34 offen lds
    s_add_u32 m0, s48, 3072
    s_add_u32 s34, s35, 24576
    buffer_load_dwordx4 v3, s[64:67], s34 offen lds
    s_add_u32 m0, s48, 4096
    s_add_u32 s34, s35, 32768
    buffer_load_dwordx4 v3, s[64:67], s34 offen lds
    s_add_u32 m0, s48, 5120
    s_add_u32 s34, s35, 40960
    buffer_load_dwordx4 v3, s[64:67], s34 offen lds
    s_add_u32 m0, s48, 6144
    s_add_u32 s34, s35, 49152
    buffer_load_dwordx4 v3, s[64:67], s34 offen lds
    s_add_u32 m0, s48, 7168
    s_add_u32 s34, s35, 57344
    buffer_load_dwordx4 v3, s[64:67], s34 offen lds
    s_add_u32 s35, s33, 65536
    s_add_u32 m0, s48, 8192
    s_add_u32 s34, s35, 0
    buffer_load_dwordx4 v3, s[64:67], s34 offen lds
    s_add_u32 m0, s48, 9216
    s_add_u32 s34, s35, 8192
    buffer_load_dwordx4 v3, s[64:67], s34 offen lds
    s_add_u32 m0, s48, 10240
    s_add_u32 s34, s35, 16384
    buffer_load_dwordx4 v3, s[64:67], s34 offen lds
    s_add_u32 m0, s48, 11264
    s_add_u32 s34, s35, 24576
    buffer_load_dwordx4 v3, s[64:67], s34 offen lds
    s_add_u32 m0, s48, 12288
    s_add_u32 s34, s35, 32768
    buffer_load_dwordx4 v3, s[64:67], s34 offen lds
    s_add_u32 m0, s48, 13312
    s_add_u32 s34, s35, 40960
    buffer_load_dwordx4 v3, s[64:67], s34 offen lds
    s_add_u32 m0, s48, 14336
    s_add_u32 s34, s35, 49152
    buffer_load_dwordx4 v3, s[64:67], s34 offen lds
    s_add_u32 m0, s48, 15360
    s_add_u32 s34, s35, 57344
    buffer_load_dwordx4 v3, s[64:67], s34 offen lds
    s_add_u32 s35, s31, 4096
    s_add_u32 s36, s31, 8192
    s_add_u32 s37, s31, 12288
    s_cmp_lg_u32 s29, 0
    s_cbranch_scc1 L_noall_52
    v_lshlrev_b32 v14, 7, v1
    s_mov_b32 s42, 0
L_poll_53:
    s_mov_b32 s49, 0x1430000
    buffer_load_dword v16, v14, s[20:23], s49 offen sc0 sc1
    s_mov_b32 s49, 0x1432000
    buffer_load_dword v17, v14, s[20:23], s49 offen sc0 sc1
    s_mov_b32 s49, 0x1434000
    buffer_load_dword v18, v14, s[20:23], s49 offen sc0 sc1
    s_mov_b32 s49, 0x1436000
    buffer_load_dword v19, v14, s[20:23], s49 offen sc0 sc1
L_poll_53_w:
    s_add_u32 s42, s42, 1
    s_waitcnt vmcnt(0)
    v_xor_b32 v16, s3, v16
    v_xor_b32 v17, s3, v17
    v_xor_b32 v18, s3, v18
    v_xor_b32 v19, s3, v19
    v_or_b32 v16, v16, v17
    v_or_b32 v16, v16, v18
    v_or_b32 v16, v16, v19
    v_cmp_ne_u32 vcc, 0, v16
    s_nop 4
    s_cbranch_vccz L_poll_53_d
    s_sleep 4
    s_cmp_lt_u32 s42, 0x100000
    s_cbranch_scc1 L_poll_53
L_poll_53_d:
    s_cmp_lg_u32 s2, 0
    s_cbranch_scc1 L_noepoch_54
    s_mov_b32 s49, 0x1404000
    v_mov_b32 v14, s3
    v_mov_b32 v15, 0
    s_mov_b64 exec, 1
    buffer_store_dword v14, v15, s[20:23], s49 offen sc0 sc1
    s_mov_b64 exec, -1
L_noepoch_54:
L_noall_52:
    s_waitcnt vmcnt(0)
    s_mov_b64 exec, 1
    ds_add_u32 v10, v12 offset:44
    s_mov_b64 exec, -1
    v_permlane32_swap_b32 v24, v26
    v_permlane32_swap_b32 v25, v27
    v_permlane32_swap_b32 v28, v30
    v_permlane32_swap_b32 v29, v31
    s_mov_b32 s43, 0
L_lw_55:
    ds_read_b32 v13, v10 offset:44
    s_waitcnt lgkmcnt(0)
    v_readfirstlane_b32 s42, v13
    s_add_u32 s43, s43, 1
    s_cmp_ge_u32 s42, 4
    s_cbranch_scc1 L_lw_55_d
    s_sleep 1
    s_cmp_lt_u32 s43, 0x2000000
    s_cbranch_scc1 L_lw_55
L_lw_55_d:
    s_mov_b32 s43, 0
L_lw_56:
    ds_read_b32 v13, v10 offset:40
    s_waitcnt lgkmcnt(0)
    v_readfirstlane_b32 s42, v13
    s_add_u32 s43, s43, 1
    s_cmp_ge_u32 s42, 1
    s_cbranch_scc1 L_lw_56_d
    s_sleep 8
    s_cmp_lt_u32 s43, 0x2000000
    s_cbranch_scc1 L_lw_56
L_lw_56_d:
    s_mov_b32 s43, 0
L_lw_57:
    ds_read_b32 v13, v10 offset:40
    s_waitcnt lgkmcnt(0)
    v_readfirstlane_b32 s42, v13
    s_add_u32 s43, s43, 1
    s_cmp_ge_u32 s42, 8
    s_cbranch_scc1 L_lw_57_d
    s_sleep 1
    s_cmp_lt_u32 s43, 0x2000000
    s_cbranch_scc1 L_lw_57
L_lw_57_d:
    s_movk_i32 s50, 0xff
    s_mov_b32 s51, 0
    buffer_load_dwordx4 v[32:35], v2, s[20:23], s31 offen offset:0 sc0 sc1
    buffer_load_dwordx4 v[36:39], v2, s[20:23], s31 offen offset:1024 sc0 sc1
    buffer_load_dwordx4 v[40:43], v2, s[20:23], s31 offen offset:2048 sc0 sc1
    buffer_load_dwordx4 v[44:47], v2, s[20:23], s31 offen offset:3072 sc0 sc1
    ds_write_b128 v6, v[112:115] offset:4096
    ds_write_b128 v6, v[116:119] offset:5120
    ds_write_b128 v6, v[120:123] offset:6144
    ds_write_b128 v6, v[124:127] offset:7168
    buffer_load_dwordx4 v[48:51], v2, s[20:23], s35 offen offset:0 sc0 sc1
    buffer_load_dwordx4 v[52:55], v2, s[20:23], s35 offen offset:1024 sc0 sc1
    ds_write_b128 v6, v[128:131] offset:8192
    ds_write_b128 v6, v[132:135] offset:9216
    ds_write_b128 v6, v[136:139] offset:10240
    ds_write_b128 v6, v[140:143] offset:11264
    buffer_load_dwordx4 v[56:59], v2, s[20:23], s35 offen offset:2048 sc0 sc1
    buffer_load_dwordx4 v[60:63], v2, s[20:23], s35 offen offset:3072 sc0 sc1
    ds_write_b128 v6, v[144:147] offset:12288
    ds_write_b128 v6, v[148:151] offset:13312
    ds_write_b128 v6, v[152:155] offset:14336
    ds_write_b128 v6, v[156:159] offset:15360
    buffer_load_dwordx4 v[64:67], v2, s[20:23], s36 offen offset:0 sc0 sc1
    buffer_load_dwordx4 v[68:71], v2, s[20:23], s36 offen offset:1024 sc0 sc1
    s_waitcnt lgkmcnt(0)
    s_mov_b64 exec, 1
    ds_add_u32 v10, v12 offset:16
    s_mov_b64 exec, -1
    buffer_load_dwordx4 v[72:75], v2, s[20:23], s36 offen offset:2048 sc0 sc1
    buffer_load_dwordx4 v[76:79], v2, s[20:23], s36 offen offset:3072 sc0 sc1
    s_mov_b32 s43, 0
L_lw_59:
    ds_read_b32 v13, v10 offset:16
    s_waitcnt lgkmcnt(0)
    v_readfirstlane_b32 s42, v13
    s_add_u32 s43, s43, 1
    s_cmp_ge_u32 s42, 4
    s_cbranch_scc1 L_lw_59_d
    s_cmp_lt_u32 s43, 0x2000000
    s_cbranch_scc1 L_lw_59
L_lw_59_d:
    ds_read_b128 v[112:115], v7 offset:4096
    ds_read_b128 v[116:119], v7 offset:5120
    ds_read_b128 v[120:123], v7 offset:6144
    ds_read_b128 v[124:127], v7 offset:7168
    ds_read_b128 v[128:131], v8 offset:8192
    ds_read_b128 v[132:135], v8 offset:9216
    ds_read_b128 v[136:139], v8 offset:10240
    ds_read_b128 v[140:143], v8 offset:11264
    ds_read_b128 v[144:147], v9 offset:12288
    ds_read_b128 v[148:151], v9 offset:13312
    ds_read_b128 v[152:155], v9 offset:14336
    ds_read_b128 v[156:159], v9 offset:15360
    buffer_load_dwordx4 v[80:83], v2, s[20:23], s37 offen offset:0 sc0 sc1
    buffer_load_dwordx4 v[84:87], v2, s[20:23], s37 offen offset:1024 sc0 sc1
    buffer_load_dwordx4 v[88:91], v2, s[20:23], s37 offen offset:2048 sc0 sc1
    buffer_load_dwordx4 v[92:95], v2, s[20:23], s37 offen offset:3072 sc0 sc1
    s_waitcnt lgkmcnt(8)
    v_pk_add_f32 v[96:97], v[96:97], v[112:113]
    v_pk_add_f32 v[98:99], v[98:99], v[114:115]
    v_pk_add_f32 v[100:101], v[100:101], v[116:117]
    v_pk_add_f32 v[102:103], v[102:103], v[118:119]
    v_pk_add_f32 v[104:105], v[104:105], v[120:121]
    v_pk_add_f32 v[106:107], v[106:107], v[122:123]
    v_pk_add_f32 v[108:109], v[108:109], v[124:125]
    v_pk_add_f32 v[110:111], v[110:111], v[126:127]
    s_waitcnt lgkmcnt(4)
    v_pk_add_f32 v[96:97], v[96:97], v[128:129]
    v_pk_add_f32 v[98:99], v[98:99], v[130:131]
    v_pk_add_f32 v[100:101], v[100:101], v[132:133]
    v_pk_add_f32 v[102:103], v[102:103], v[134:135]
    v_pk_add_f32 v[104:105], v[104:105], v[136:137]
    v_pk_add_f32 v[106:107], v[106:107], v[138:139]
    v_pk_add_f32 v[108:109], v[108:109], v[140:141]
    v_pk_add_f32 v[110:111], v[110:111], v[142:143]
    s_waitcnt lgkmcnt(0)
    v_pk_add_f32 v[96:97], v[96:97], v[144:145]
    v_pk_add_f32 v[98:99], v[98:99], v[146:147]
    v_pk_add_f32 v[100:101], v[100:101], v[148:149]
    v_pk_add_f32 v[102:103], v[102:103], v[150:151]
    v_pk_add_f32 v[104:105], v[104:105], v[152:153]
    v_pk_add_f32 v[106:107], v[106:107], v[154:155]
    v_pk_add_f32 v[108:109], v[108:109], v[156:157]
    v_pk_add_f32 v[110:111], v[110:111], v[158:159]
    ds_read_b64_tr_b16 v[128:129], v4 offset:0
    ds_read_b64_tr_b16 v[130:131], v4 offset:1024
    ds_read_b64_tr_b16 v[132:133], v5 offset:0
    ds_read_b64_tr_b16 v[134:135], v5 offset:1024
    ds_read_b64_tr_b16 v[136:137], v4 offset:2048
    ds_read_b64_tr_b16 v[138:139], v4 offset:3072
    ds_read_b64_tr_b16 v[140:141], v5 offset:2048
    ds_read_b64_tr_b16 v[142:143], v5 offset:3072
    s_lshl_b32 s49, s29, 12
    s_add_u32 s49, s49, 133120
    v_add_u32 v6, s49, v2
    s_xor_b32 s49, s29, 2
    s_lshl_b32 s49, s49, 12
    s_add_u32 s49, s49, 133120
    v_add_u32 v8, s49, v2
    v_cvt_pk_bf16_f32 v16, v96, v97
    v_cvt_pk_bf16_f32 v17, v98, v99
    v_cvt_pk_bf16_f32 v18, v100, v101
    v_cvt_pk_bf16_f32 v19, v102, v103
    v_cvt_pk_bf16_f32 v20, v104, v105
    v_cvt_pk_bf16_f32 v21, v106, v107
    v_cvt_pk_bf16_f32 v22, v108, v109
    v_cvt_pk_bf16_f32 v23, v110, v111
    v_lshlrev_b32 v96, 16, v16
    v_and_b32 v97, s41, v16
    v_lshlrev_b32 v98, 16, v17
    v_and_b32 v99, s41, v17
    v_lshlrev_b32 v100, 16, v18
    v_and_b32 v101, s41, v18
    v_lshlrev_b32 v102, 16, v19
    v_and_b32 v103, s41, v19
    v_lshlrev_b32 v104, 16, v20
    v_and_b32 v105, s41, v20
    v_lshlrev_b32 v106, 16, v21
    v_and_b32 v107, s41, v21
    v_lshlrev_b32 v108, 16, v22
    v_and_b32 v109, s41, v22
    v_lshlrev_b32 v110, 16, v23
    v_and_b32 v111, s41, v23
    v_mul_f32 v112, 0xbfb8aa3b, v96
    v_mul_f32 v113, 0xbfb8aa3b, v97
    v_mul_f32 v114, 0xbfb8aa3b, v98
    v_mul_f32 v115, 0xbfb8aa3b, v99
    v_mul_f32 v116, 0xbfb8aa3b, v100
    v_mul_f32 v117, 0xbfb8aa3b, v101
    v_mul_f32 v118, 0xbfb8aa3b, v102
    v_mul_f32 v119, 0xbfb8aa3b, v103
    v_mul_f32 v120, 0xbfb8aa3b, v104
    v_mul_f32 v121, 0xbfb8aa3b, v105
    v_mul_f32 v122, 0xbfb8aa3b, v106
    v_mul_f32 v123, 0xbfb8aa3b, v107
    v_mul_f32 v124, 0xbfb8aa3b, v108
    v_mul_f32 v125, 0xbfb8aa3b, v109
    v_mul_f32 v126, 0xbfb8aa3b, v110
    v_mul_f32 v127, 0xbfb8aa3b, v111
    v_exp_f32 v112, v112
    v_exp_f32 v113, v113
    v_exp_f32 v114, v114
    v_exp_f32 v115, v115
    v_exp_f32 v116, v116
    v_exp_f32 v117, v117
    v_exp_f32 v118, v118
    v_exp_f32 v119, v119
    v_exp_f32 v120, v120
    v_exp_f32 v121, v121
    v_exp_f32 v122, v122
    v_exp_f32 v123, v123
    v_exp_f32 v124, v124
    v_exp_f32 v125, v125
    v_exp_f32 v126, v126
    v_exp_f32 v127, v127
    v_add_f32 v112, 1.0, v112
    v_add_f32 v113, 1.0, v113
    v_add_f32 v114, 1.0, v114
    v_add_f32 v115, 1.0, v115
    v_add_f32 v116, 1.0, v116
    v_add_f32 v117, 1.0, v117
    v_add_f32 v118, 1.0, v118
    v_add_f32 v119, 1.0, v119
    v_add_f32 v120, 1.0, v120
    v_add_f32 v121, 1.0, v121
    v_add_f32 v122, 1.0, v122
    v_add_f32 v123, 1.0, v123
    v_add_f32 v124, 1.0, v124
    v_add_f32 v125, 1.0, v125
    v_add_f32 v126, 1.0, v126
    v_add_f32 v127, 1.0, v127
    v_rcp_f32 v112, v112
    v_rcp_f32 v113, v113
    v_rcp_f32 v114, v114
    v_rcp_f32 v115, v115
    v_rcp_f32 v116, v116
    v_rcp_f32 v117, v117
    v_rcp_f32 v118, v118
    v_rcp_f32 v119, v119
    v_rcp_f32 v120, v120
    v_rcp_f32 v121, v121
    v_rcp_f32 v122, v122
    v_rcp_f32 v123, v123
    v_rcp_f32 v124, v124
    v_rcp_f32 v125, v125
    v_rcp_f32 v126, v126
    v_rcp_f32 v127, v127
    v_mov_b32 v16, 0
    v_mov_b32 v17, 0
    v_mov_b32 v18, 0
    v_mov_b32 v19, 0
    v_pk_mul_f32 v[96:97], v[96:97], v[112:113]
    v_pk_mul_f32 v[98:99], v[98:99], v[114:115]
    v_pk_mul_f32 v[100:101], v[100:101], v[116:117]
    v_pk_mul_f32 v[102:103], v[102:103], v[118:119]
    v_pk_mul_f32 v[104:105], v[104:105], v[120:121]
    v_pk_mul_f32 v[106:107], v[106:107], v[122:123]
    v_pk_mul_f32 v[108:109], v[108:109], v[124:125]
    v_pk_mul_f32 v[110:111], v[110:111], v[126:127]
    v_mfma_f32_32x32x16_bf16 v[112:127], v[16:19], v[16:19], 0
    v_cvt_pk_bf16_f32 v160, v96, v97
    v_cvt_pk_bf16_f32 v161, v98, v99
    v_cvt_pk_bf16_f32 v162, v100, v101
    v_cvt_pk_bf16_f32 v163, v102, v103
    v_cvt_pk_bf16_f32 v164, v104, v105
    v_cvt_pk_bf16_f32 v165, v106, v107
    v_cvt_pk_bf16_f32 v166, v108, v109
    v_cvt_pk_bf16_f32 v167, v110, v111
    v_mfma_f32_32x32x16_bf16 v[96:111], v[16:19], v[16:19], 0
    s_waitcnt vmcnt(14)
    v_max3_u32 v13, v32, v33, v34
    v_max3_u32 v13, v13, v35, v36
    v_max3_u32 v13, v13, v37, v38
    v_max_u32 v13, v13, v39
    v_cmp_eq_u32 vcc, -1, v13
    s_nop 4
    s_cbranch_vccnz L_ornd_58_c
    s_waitcnt lgkmcnt(0)
    v_mfma_f32_32x32x16_bf16 v[112:127], v[132:135], v[32:35], v[112:127]
    ds_read_b64_tr_b16 v[144:145], v4 offset:4096
    ds_read_b64_tr_b16 v[146:147], v4 offset:5120
    ds_read_b64_tr_b16 v[148:149], v5 offset:4096
    ds_read_b64_tr_b16 v[150:151], v5 offset:5120
    v_mfma_f32_32x32x16_bf16 v[96:111], v[128:131], v[32:35], v[96:111]
    ds_read_b64_tr_b16 v[152:153], v4 offset:6144
    ds_read_b64_tr_b16 v[154:155], v4 offset:7168
    ds_read_b64_tr_b16 v[156:157], v5 offset:6144
    ds_read_b64_tr_b16 v[158:159], v5 offset:7168
    v_mfma_f32_32x32x16_bf16 v[112:127], v[140:143], v[36:39], v[112:127]
    s_waitcnt vmcnt(12)
    v_max3_u32 v13, v40, v41, v42
    v_max3_u32 v13, v13, v43, v44
    v_max3_u32 v13, v13, v45, v46
    v_max_u32 v13, v13, v47
    v_cmp_eq_u32 vcc, -1, v13
    v_mfma_f32_32x32x16_bf16 v[96:111], v[136:139], v[36:39], v[96:111]
    s_bitset0_b32 s50, 0
    s_nop 2
    s_cbranch_vccnz L_ornd_58_c
    s_waitcnt lgkmcnt(0)
    v_mfma_f32_32x32x16_bf16 v[112:127], v[148:151], v[40:43], v[112:127]
    ds_read_b64_tr_b16 v[128:129], v4 offset:8192
    ds_read_b64_tr_b16 v[130:131], v4 offset:9216
    ds_read_b64_tr_b16 v[132:133], v5 offset:8192
    ds_read_b64_tr_b16 v[134:135], v5 offset:9216
    v_mfma_f32_32x32x16_bf16 v[96:111], v[144:147], v[40:43], v[96:111]
    ds_read_b64_tr_b16 v[136:137], v4 offset:10240
    ds_read_b64_tr_b16 v[138:139], v4 offset:11264
    ds_read_b64_tr_b16 v[140:141], v5 offset:10240
    ds_read_b64_tr_b16 v[142:143], v5 offset:11264
    v_mfma_f32_32x32x16_bf16 v[112:127], v[156:159], v[44:47], v[112:127]
    s_waitcnt vmcnt(10)
    v_max3_u32 v13, v48, v49, v50
    v_max3_u32 v13, v13, v51, v52
    v_max3_u32 v13, v13, v53, v54
    v_max_u32 v13, v13, v55
    v_cmp_eq_u32 vcc, -1, v13
    v_mfma_f32_32x32x16_bf16 v[96:111], v[152:155], v[44:47], v[96:111]
    s_bitset0_b32 s50, 1
    s_nop 2
    s_cbranch_vccnz L_ornd_58_c
    s_waitcnt lgkmcnt(0)
    v_mfma_f32_32x32x16_bf16 v[112:127], v[132:135], v[48:51], v[112:127]
    ds_read_b64_tr_b16 v[144:145], v4 offset:12288
    ds_read_b64_tr_b16 v[146:147], v4 offset:13312
    ds_read_b64_tr_b16 v[148:149], v5 offset:12288
    ds_read_b64_tr_b16 v[150:151], v5 offset:13312
    v_mfma_f32_32x32x16_bf16 v[96:111], v[128:131], v[48:51], v[96:111]
    ds_read_b64_tr_b16 v[152:153], v4 offset:14336
    ds_read_b64_tr_b16 v[154:155], v4 offset:15360
    ds_read_b64_tr_b16 v[156:157], v5 offset:14336
    ds_read_b64_tr_b16 v[158:159], v5 offset:15360
    v_mfma_f32_32x32x16_bf16 v[112:127], v[140:143], v[52:55], v[112:127]
    s_waitcnt vmcnt(8)
    v_max3_u32 v13, v56, v57, v58
    v_max3_u32 v13, v13, v59, v60
    v_max3_u32 v13, v13, v61, v62
    v_max_u32 v13, v13, v63
    v_cmp_eq_u32 vcc, -1, v13
    v_mfma_f32_32x32x16_bf16 v[96:111], v[136:139], v[52:55], v[96:111]
    s_bitset0_b32 s50, 2
    s_nop 2
    s_cbranch_vccnz L_ornd_58_c
    s_waitcnt lgkmcnt(0)
    v_mfma_f32_32x32x16_bf16 v[112:127], v[148:151], v[56:59], v[112:127]
    ds_read_b64_tr_b16 v[128:129], v4 offset:16384
    ds_read_b64_tr_b16 v[130:131], v4 offset:17408
    ds_read_b64_tr_b16 v[132:133], v5 offset:16384
    ds_read_b64_tr_b16 v[134:135], v5 offset:17408
    v_mfma_f32_32x32x16_bf16 v[96:111], v[144:147], v[56:59], v[96:111]
    ds_read_b64_tr_b16 v[136:137], v4 offset:18432
    ds_read_b64_tr_b16 v[138:139], v4 offset:19456
    ds_read_b64_tr_b16 v[140:141], v5 offset:18432
    ds_read_b64_tr_b16 v[142:143], v5 offset:19456
    v_mfma_f32_32x32x16_bf16 v[112:127], v[156:159], v[60:63], v[112:127]
    s_waitcnt vmcnt(6)
    v_max3_u32 v13, v64, v65, v66
    v_max3_u32 v13, v13, v67, v68
    v_max3_u32 v13, v13, v69, v70
    v_max_u32 v13, v13, v71
    v_cmp_eq_u32 vcc, -1, v13
    v_mfma_f32_32x32x16_bf16 v[96:111], v[152:155], v[60:63], v[96:111]
    s_bitset0_b32 s50, 3
    s_nop 2
    s_cbranch_vccnz L_ornd_58_c
    s_waitcnt lgkmcnt(0)
    v_mfma_f32_32x32x16_bf16 v[112:127], v[132:135], v[64:67], v[112:127]
    ds_read_b64_tr_b16 v[144:145], v4 offset:20480
    ds_read_b64_tr_b16 v[146:147], v4 offset:21504
    ds_read_b64_tr_b16 v[148:149], v5 offset:20480
    ds_read_b64_tr_b16 v[150:151], v5 offset:21504
    v_mfma_f32_32x32x16_bf16 v[96:111], v[128:131], v[64:67], v[96:111]
    ds_read_b64_tr_b16 v[152:153], v4 offset:22528
    ds_read_b64_tr_b16 v[154:155], v4 offset:23552
    ds_read_b64_tr_b16 v[156:157], v5 offset:22528
    ds_read_b64_tr_b16 v[158:159], v5 offset:23552
    v_mfma_f32_32x32x16_bf16 v[112:127], v[140:143], v[68:71], v[112:127]
    s_waitcnt vmcnt(4)
    v_max3_u32 v13, v72, v73, v74
    v_max3_u32 v13, v13, v75, v76
    v_max3_u32 v13, v13, v77, v78
    v_max_u32 v13, v13, v79
    v_cmp_eq_u32 vcc, -1, v13
    v_mfma_f32_32x32x16_bf16 v[96:111], v[136:139], v[68:71], v[96:111]
    s_bitset0_b32 s50, 4
    s_nop 2
    s_cbranch_vccnz L_ornd_58_c
    s_waitcnt lgkmcnt(0)
    v_mfma_f32_32x32x16_bf16 v[112:127], v[148:151], v[72:75], v[112:127]
    ds_read_b64_tr_b16 v[128:129], v4 offset:24576
    ds_read_b64_tr_b16 v[130:131], v4 offset:25600
    ds_read_b64_tr_b16 v[132:133], v5 offset:24576
    ds_read_b64_tr_b16 v[134:135], v5 offset:25600
    v_mfma_f32_32x32x16_bf16 v[96:111], v[144:147], v[72:75], v[96:111]
    ds_read_b64_tr_b16 v[136:137], v4 offset:26624
    ds_read_b64_tr_b16 v[138:139], v4 offset:27648
    ds_read_b64_tr_b16 v[140:141], v5 offset:26624
    ds_read_b64_tr_b16 v[142:143], v5 offset:27648
    v_mfma_f32_32x32x16_bf16 v[112:127], v[156:159], v[76:79], v[112:127]
    s_waitcnt vmcnt(2)
    v_max3_u32 v13, v80, v81, v82
    v_max3_u32 v13, v13, v83, v84
    v_max3_u32 v13, v13, v85, v86
    v_max_u32 v13, v13, v87
    v_cmp_eq_u32 vcc, -1, v13
    v_mfma_f32_32x32x16_bf16 v[96:111], v[152:155], v[76:79], v[96:111]
    s_bitset0_b32 s50, 5
    s_nop 2
    s_cbranch_vccnz L_ornd_58_c
    s_waitcnt lgkmcnt(0)
    v_mfma_f32_32x32x16_bf16 v[112:127], v[132:135], v[80:83], v[112:127]
    ds_read_b64_tr_b16 v[144:145], v4 offset:28672
    ds_read_b64_tr_b16 v[146:147], v4 offset:29696
    ds_read_b64_tr_b16 v[148:149], v5 offset:28672
    ds_read_b64_tr_b16 v[150:151], v5 offset:29696
    v_mfma_f32_32x32x16_bf16 v[96:111], v[128:131], v[80:83], v[96:111]
    ds_read_b64_tr_b16 v[152:153], v4 offset:30720
    ds_read_b64_tr_b16 v[154:155], v4 offset:31744
    ds_read_b64_tr_b16 v[156:157], v5 offset:30720
    ds_read_b64_tr_b16 v[158:159], v5 offset:31744
    v_mfma_f32_32x32x16_bf16 v[112:127], v[140:143], v[84:87], v[112:127]
    s_waitcnt vmcnt(0)
    v_max3_u32 v13, v88, v89, v90
    v_max3_u32 v13, v13, v91, v92
    v_max3_u32 v13, v13, v93, v94
    v_max_u32 v13, v13, v95
    v_cmp_eq_u32 vcc, -1, v13
    v_mfma_f32_32x32x16_bf16 v[96:111], v[136:139], v[84:87], v[96:111]
    s_bitset0_b32 s50, 6
    s_nop 2
    s_cbranch_vccnz L_ornd_58_c
    s_waitcnt lgkmcnt(0)
    v_mfma_f32_32x32x16_bf16 v[112:127], v[148:151], v[88:91], v[112:127]
    v_mfma_f32_32x32x16_bf16 v[96:111], v[144:147], v[88:91], v[96:111]
    v_mfma_f32_32x32x16_bf16 v[112:127], v[156:159], v[92:95], v[112:127]
    v_mfma_f32_32x32x16_bf16 v[96:111], v[152:155], v[92:95], v[96:111]
L_ornd_58_e:
    v_lshlrev_b32 v32, 16, v160
    v_and_b32 v33, s41, v160
    v_lshlrev_b32 v34, 16, v161
    v_and_b32 v35, s41, v161
    v_lshlrev_b32 v36, 16, v162
    v_and_b32 v37, s41, v162
    v_lshlrev_b32 v38, 16, v163
    v_and_b32 v39, s41, v163
    v_lshlrev_b32 v40, 16, v164
    v_and_b32 v41, s41, v164
    v_lshlrev_b32 v42, 16, v165
    v_and_b32 v43, s41, v165
    ds_write_b128 v6, v[112:115] offset:0
    ds_write_b128 v6, v[116:119] offset:1024
    ds_write_b128 v6, v[120:123] offset:2048
    ds_write_b128 v6, v[124:127] offset:3072
    v_lshlrev_b32 v44, 16, v166
    v_and_b32 v45, s41, v166
    v_lshlrev_b32 v46, 16, v167
    v_and_b32 v47, s41, v167
    v_lshlrev_b32 v48, 16, v24
    v_and_b32 v49, s41, v24
    v_lshlrev_b32 v50, 16, v25
    v_and_b32 v51, s41, v25
    v_lshlrev_b32 v52, 16, v26
    v_and_b32 v53, s41, v26
    v_lshlrev_b32 v54, 16, v27
    v_and_b32 v55, s41, v27
    v_lshlrev_b32 v56, 16, v28
    v_and_b32 v57, s41, v28
    v_lshlrev_b32 v58, 16, v29
    v_and_b32 v59, s41, v29
    v_lshlrev_b32 v60, 16, v30
    v_and_b32 v61, s41, v30
    v_lshlrev_b32 v62, 16, v31
    v_and_b32 v63, s41, v31
    s_waitcnt lgkmcnt(0)
    s_barrier
    ds_read_b128 v[112:115], v8 offset:0
    ds_read_b128 v[116:119], v8 offset:1024
    ds_read_b128 v[120:123], v8 offset:2048
    ds_read_b128 v[124:127], v8 offset:3072
    v_pk_fma_f32 v[48:49], v[96:97], v[32:33], v[48:49]
    v_pk_fma_f32 v[50:51], v[98:99], v[34:35], v[50:51]
    v_pk_fma_f32 v[52:53], v[100:101], v[36:37], v[52:53]
    v_pk_fma_f32 v[54:55], v[102:103], v[38:39], v[54:55]
    v_pk_fma_f32 v[56:57], v[104:105], v[40:41], v[56:57]
    v_pk_fma_f32 v[58:59], v[106:107], v[42:43], v[58:59]
    v_pk_fma_f32 v[60:61], v[108:109], v[44:45], v[60:61]
    v_pk_fma_f32 v[62:63], v[110:111], v[46:47], v[62:63]
    s_waitcnt lgkmcnt(0)
    v_pk_fma_f32 v[48:49], v[112:113], v[32:33], v[48:49]
    v_pk_fma_f32 v[50:51], v[114:115], v[34:35], v[50:51]
    v_pk_fma_f32 v[52:53], v[116:117], v[36:37], v[52:53]
    v_pk_fma_f32 v[54:55], v[118:119], v[38:39], v[54:55]
    v_pk_fma_f32 v[56:57], v[120:121], v[40:41], v[56:57]
    v_pk_fma_f32 v[58:59], v[122:123], v[42:43], v[58:59]
    v_pk_fma_f32 v[60:61], v[124:125], v[44:45], v[60:61]
    v_pk_fma_f32 v[62:63], v[126:127], v[46:47], v[62:63]
    v_cvt_pk_bf16_f32 v16, v48, v49
    v_cvt_pk_bf16_f32 v17, v50, v51
    v_cvt_pk_bf16_f32 v18, v52, v53
    v_cvt_pk_bf16_f32 v19, v54, v55
    v_cvt_pk_bf16_f32 v20, v56, v57
    v_cvt_pk_bf16_f32 v21, v58, v59
    v_cvt_pk_bf16_f32 v22, v60, v61
    v_cvt_pk_bf16_f32 v23, v62, v63
    s_nop 1
    v_permlane32_swap_b32 v16, v18
    v_permlane32_swap_b32 v17, v19
    v_permlane32_swap_b32 v20, v22
    v_permlane32_swap_b32 v21, v23
    buffer_store_dwordx4 v[16:19], v11, s[68:71], s45 offen
    buffer_store_dwordx4 v[20:23], v11, s[68:71], s45 offen offset:32
    s_endpgm
L_ornd_58:
    s_mov_b32 s49, s50
L_ornd_58_la:
    s_bitcmp1_b32 s49, 0
    s_cbranch_scc1 L_ornd_58_l0
    s_bitcmp1_b32 s49, 1
    s_cbranch_scc1 L_ornd_58_l1
    s_bitcmp1_b32 s49, 2
    s_cbranch_scc1 L_ornd_58_l2
    s_bitcmp1_b32 s49, 3
    s_cbranch_scc1 L_ornd_58_l3
    s_bitcmp1_b32 s49, 4
    s_cbranch_scc1 L_ornd_58_l4
    s_bitcmp1_b32 s49, 5
    s_cbranch_scc1 L_ornd_58_l5
    s_bitcmp1_b32 s49, 6
    s_cbranch_scc1 L_ornd_58_l6
    s_bitcmp1_b32 s49, 7
    s_cbranch_scc1 L_ornd_58_l7
    s_branch L_ornd_58_w
L_ornd_58_l0:
    buffer_load_dwordx4 v[32:35], v2, s[20:23], s31 offen offset:0 sc0 sc1
    buffer_load_dwordx4 v[36:39], v2, s[20:23], s31 offen offset:1024 sc0 sc1
    s_bitset0_b32 s49, 0
    s_bitcmp1_b32 s49, 1
    s_cbranch_scc0 L_ornd_58_la
L_ornd_58_l1:
    buffer_load_dwordx4 v[40:43], v2, s[20:23], s31 offen offset:2048 sc0 sc1
    buffer_load_dwordx4 v[44:47], v2, s[20:23], s31 offen offset:3072 sc0 sc1
    s_bitset0_b32 s49, 1
    s_bitcmp1_b32 s49, 2
    s_cbranch_scc0 L_ornd_58_la
L_ornd_58_l2:
    buffer_load_dwordx4 v[48:51], v2, s[20:23], s35 offen offset:0 sc0 sc1
    buffer_load_dwordx4 v[52:55], v2, s[20:23], s35 offen offset:1024 sc0 sc1
    s_bitset0_b32 s49, 2
    s_bitcmp1_b32 s49, 3
    s_cbranch_scc0 L_ornd_58_la
L_ornd_58_l3:
    buffer_load_dwordx4 v[56:59], v2, s[20:23], s35 offen offset:2048 sc0 sc1
    buffer_load_dwordx4 v[60:63], v2, s[20:23], s35 offen offset:3072 sc0 sc1
    s_bitset0_b32 s49, 3
    s_bitcmp1_b32 s49, 4
    s_cbranch_scc0 L_ornd_58_la
L_ornd_58_l4:
    buffer_load_dwordx4 v[64:67], v2, s[20:23], s36 offen offset:0 sc0 sc1
    buffer_load_dwordx4 v[68:71], v2, s[20:23], s36 offen offset:1024 sc0 sc1
    s_bitset0_b32 s49, 4
    s_bitcmp1_b32 s49, 5
    s_cbranch_scc0 L_ornd_58_la
L_ornd_58_l5:
    buffer_load_dwordx4 v[72:75], v2, s[20:23], s36 offen offset:2048 sc0 sc1
    buffer_load_dwordx4 v[76:79], v2, s[20:23], s36 offen offset:3072 sc0 sc1
    s_bitset0_b32 s49, 5
    s_bitcmp1_b32 s49, 6
    s_cbranch_scc0 L_ornd_58_la
L_ornd_58_l6:
    buffer_load_dwordx4 v[80:83], v2, s[20:23], s37 offen offset:0 sc0 sc1
    buffer_load_dwordx4 v[84:87], v2, s[20:23], s37 offen offset:1024 sc0 sc1
    s_bitset0_b32 s49, 6
    s_bitcmp1_b32 s49, 7
    s_cbranch_scc0 L_ornd_58_la
L_ornd_58_l7:
    buffer_load_dwordx4 v[88:91], v2, s[20:23], s37 offen offset:2048 sc0 sc1
    buffer_load_dwordx4 v[92:95], v2, s[20:23], s37 offen offset:3072 sc0 sc1
L_ornd_58_w:
    s_waitcnt vmcnt(0)
L_ornd_58_c:
    s_mov_b32 s49, s50
L_ornd_58_ca:
    s_cmp_eq_u32 s50, 0
    s_cbranch_scc1 L_ornd_58_e
    s_bitcmp1_b32 s49, 0
    s_cbranch_scc1 L_ornd_58_k0
    s_bitcmp1_b32 s49, 1
    s_cbranch_scc1 L_ornd_58_k1
    s_bitcmp1_b32 s49, 2
    s_cbranch_scc1 L_ornd_58_k2
    s_bitcmp1_b32 s49, 3
    s_cbranch_scc1 L_ornd_58_k3
    s_bitcmp1_b32 s49, 4
    s_cbranch_scc1 L_ornd_58_k4
    s_bitcmp1_b32 s49, 5
    s_cbranch_scc1 L_ornd_58_k5
    s_bitcmp1_b32 s49, 6
    s_cbranch_scc1 L_ornd_58_k6
    s_bitcmp1_b32 s49, 7
    s_cbranch_scc1 L_ornd_58_k7
    s_branch L_ornd_58_r
L_ornd_58_k0:
    ds_read_b64_tr_b16 v[128:129], v4 offset:0
    ds_read_b64_tr_b16 v[130:131], v4 offset:1024
    ds_read_b64_tr_b16 v[132:133], v5 offset:0
    ds_read_b64_tr_b16 v[134:135], v5 offset:1024
    ds_read_b64_tr_b16 v[136:137], v4 offset:2048
    ds_read_b64_tr_b16 v[138:139], v4 offset:3072
    ds_read_b64_tr_b16 v[140:141], v5 offset:2048
    ds_read_b64_tr_b16 v[142:143], v5 offset:3072
    s_waitcnt vmcnt(14)
    v_max3_u32 v13, v32, v33, v34
    v_max3_u32 v13, v13, v35, v36
    v_max3_u32 v13, v13, v37, v38
    v_max_u32 v13, v13, v39
    v_cmp_eq_u32 vcc, -1, v13
    s_bitset0_b32 s49, 0
    s_cmp_ge_u32 s51, 0x100000
    s_cbranch_scc1 L_ornd_58_g0
    s_nop 1
    s_cbranch_vccnz L_ornd_58_ca
L_ornd_58_g0:
    s_bitset0_b32 s50, 0
    s_waitcnt lgkmcnt(0)
    v_mfma_f32_32x32x16_bf16 v[112:127], v[132:135], v[32:35], v[112:127]
    v_mfma_f32_32x32x16_bf16 v[96:111], v[128:131], v[32:35], v[96:111]
    v_mfma_f32_32x32x16_bf16 v[112:127], v[140:143], v[36:39], v[112:127]
    v_mfma_f32_32x32x16_bf16 v[96:111], v[136:139], v[36:39], v[96:111]
    s_bitcmp1_b32 s49, 1
    s_cbranch_scc0 L_ornd_58_ca
L_ornd_58_k1:
    ds_read_b64_tr_b16 v[128:129], v4 offset:4096
    ds_read_b64_tr_b16 v[130:131], v4 offset:5120
    ds_read_b64_tr_b16 v[132:133], v5 offset:4096
    ds_read_b64_tr_b16 v[134:135], v5 offset:5120
    ds_read_b64_tr_b16 v[136:137], v4 offset:6144
    ds_read_b64_tr_b16 v[138:139], v4 offset:7168
    ds_read_b64_tr_b16 v[140:141], v5 offset:6144
    ds_read_b64_tr_b16 v[142:143], v5 offset:7168
    s_waitcnt vmcnt(12)
    v_max3_u32 v13, v40, v41, v42
    v_max3_u32 v13, v13, v43, v44
    v_max3_u32 v13, v13, v45, v46
    v_max_u32 v13, v13, v47
    v_cmp_eq_u32 vcc, -1, v13
    s_bitset0_b32 s49, 1
    s_cmp_ge_u32 s51, 0x100000
    s_cbranch_scc1 L_ornd_58_g1
    s_nop 1
    s_cbranch_vccnz L_ornd_58_ca
L_ornd_58_g1:
    s_bitset0_b32 s50, 1
    s_waitcnt lgkmcnt(0)
    v_mfma_f32_32x32x16_bf16 v[112:127], v[132:135], v[40:43], v[112:127]
    v_mfma_f32_32x32x16_bf16 v[96:111], v[128:131], v[40:43], v[96:111]
    v_mfma_f32_32x32x16_bf16 v[112:127], v[140:143], v[44:47], v[112:127]
    v_mfma_f32_32x32x16_bf16 v[96:111], v[136:139], v[44:47], v[96:111]
    s_bitcmp1_b32 s49, 2
    s_cbranch_scc0 L_ornd_58_ca
L_ornd_58_k2:
    ds_read_b64_tr_b16 v[128:129], v4 offset:8192
    ds_read_b64_tr_b16 v[130:131], v4 offset:9216
    ds_read_b64_tr_b16 v[132:133], v5 offset:8192
    ds_read_b64_tr_b16 v[134:135], v5 offset:9216
    ds_read_b64_tr_b16 v[136:137], v4 offset:10240
    ds_read_b64_tr_b16 v[138:139], v4 offset:11264
    ds_read_b64_tr_b16 v[140:141], v5 offset:10240
    ds_read_b64_tr_b16 v[142:143], v5 offset:11264
    s_waitcnt vmcnt(10)
    v_max3_u32 v13, v48, v49, v50
    v_max3_u32 v13, v13, v51, v52
    v_max3_u32 v13, v13, v53, v54
    v_max_u32 v13, v13, v55
    v_cmp_eq_u32 vcc, -1, v13
    s_bitset0_b32 s49, 2
    s_cmp_ge_u32 s51, 0x100000
    s_cbranch_scc1 L_ornd_58_g2
    s_nop 1
    s_cbranch_vccnz L_ornd_58_ca
L_ornd_58_g2:
    s_bitset0_b32 s50, 2
    s_waitcnt lgkmcnt(0)
    v_mfma_f32_32x32x16_bf16 v[112:127], v[132:135], v[48:51], v[112:127]
    v_mfma_f32_32x32x16_bf16 v[96:111], v[128:131], v[48:51], v[96:111]
    v_mfma_f32_32x32x16_bf16 v[112:127], v[140:143], v[52:55], v[112:127]
    v_mfma_f32_32x32x16_bf16 v[96:111], v[136:139], v[52:55], v[96:111]
    s_bitcmp1_b32 s49, 3
    s_cbranch_scc0 L_ornd_58_ca
L_ornd_58_k3:
    ds_read_b64_tr_b16 v[128:129], v4 offset:12288
    ds_read_b64_tr_b16 v[130:131], v4 offset:13312
    ds_read_b64_tr_b16 v[132:133], v5 offset:12288
    ds_read_b64_tr_b16 v[134:135], v5 offset:13312
    ds_read_b64_tr_b16 v[136:137], v4 offset:14336
    ds_read_b64_tr_b16 v[138:139], v4 offset:15360
    ds_read_b64_tr_b16 v[140:141], v5 offset:14336
    ds_read_b64_tr_b16 v[142:143], v5 offset:15360
    s_waitcnt vmcnt(8)
    v_max3_u32 v13, v56, v57, v58
    v_max3_u32 v13, v13, v59, v60
    v_max3_u32 v13, v13, v61, v62
    v_max_u32 v13, v13, v63
    v_cmp_eq_u32 vcc, -1, v13
    s_bitset0_b32 s49, 3
    s_cmp_ge_u32 s51, 0x100000
    s_cbranch_scc1 L_ornd_58_g3
    s_nop 1
    s_cbranch_vccnz L_ornd_58_ca
L_ornd_58_g3:
    s_bitset0_b32 s50, 3
    s_waitcnt lgkmcnt(0)
    v_mfma_f32_32x32x16_bf16 v[112:127], v[132:135], v[56:59], v[112:127]
    v_mfma_f32_32x32x16_bf16 v[96:111], v[128:131], v[56:59], v[96:111]
    v_mfma_f32_32x32x16_bf16 v[112:127], v[140:143], v[60:63], v[112:127]
    v_mfma_f32_32x32x16_bf16 v[96:111], v[136:139], v[60:63], v[96:111]
    s_bitcmp1_b32 s49, 4
    s_cbranch_scc0 L_ornd_58_ca
L_ornd_58_k4:
    ds_read_b64_tr_b16 v[128:129], v4 offset:16384
    ds_read_b64_tr_b16 v[130:131], v4 offset:17408
    ds_read_b64_tr_b16 v[132:133], v5 offset:16384
    ds_read_b64_tr_b16 v[134:135], v5 offset:17408
    ds_read_b64_tr_b16 v[136:137], v4 offset:18432
    ds_read_b64_tr_b16 v[138:139], v4 offset:19456
    ds_read_b64_tr_b16 v[140:141], v5 offset:18432
    ds_read_b64_tr_b16 v[142:143], v5 offset:19456
    s_waitcnt vmcnt(6)
    v_max3_u32 v13, v64, v65, v66
    v_max3_u32 v13, v13, v67, v68
    v_max3_u32 v13, v13, v69, v70
    v_max_u32 v13, v13, v71
    v_cmp_eq_u32 vcc, -1, v13
    s_bitset0_b32 s49, 4
    s_cmp_ge_u32 s51, 0x100000
    s_cbranch_scc1 L_ornd_58_g4
    s_nop 1
    s_cbranch_vccnz L_ornd_58_ca
L_ornd_58_g4:
    s_bitset0_b32 s50, 4
    s_waitcnt lgkmcnt(0)
    v_mfma_f32_32x32x16_bf16 v[112:127], v[132:135], v[64:67], v[112:127]
    v_mfma_f32_32x32x16_bf16 v[96:111], v[128:131], v[64:67], v[96:111]
    v_mfma_f32_32x32x16_bf16 v[112:127], v[140:143], v[68:71], v[112:127]
    v_mfma_f32_32x32x16_bf16 v[96:111], v[136:139], v[68:71], v[96:111]
    s_bitcmp1_b32 s49, 5
    s_cbranch_scc0 L_ornd_58_ca
L_ornd_58_k5:
    ds_read_b64_tr_b16 v[128:129], v4 offset:20480
    ds_read_b64_tr_b16 v[130:131], v4 offset:21504
    ds_read_b64_tr_b16 v[132:133], v5 offset:20480
    ds_read_b64_tr_b16 v[134:135], v5 offset:21504
    ds_read_b64_tr_b16 v[136:137], v4 offset:22528
    ds_read_b64_tr_b16 v[138:139], v4 offset:23552
    ds_read_b64_tr_b16 v[140:141], v5 offset:22528
    ds_read_b64_tr_b16 v[142:143], v5 offset:23552
    s_waitcnt vmcnt(4)
    v_max3_u32 v13, v72, v73, v74
    v_max3_u32 v13, v13, v75, v76
    v_max3_u32 v13, v13, v77, v78
    v_max_u32 v13, v13, v79
    v_cmp_eq_u32 vcc, -1, v13
    s_bitset0_b32 s49, 5
    s_cmp_ge_u32 s51, 0x100000
    s_cbranch_scc1 L_ornd_58_g5
    s_nop 1
    s_cbranch_vccnz L_ornd_58_ca
L_ornd_58_g5:
    s_bitset0_b32 s50, 5
    s_waitcnt lgkmcnt(0)
    v_mfma_f32_32x32x16_bf16 v[112:127], v[132:135], v[72:75], v[112:127]
    v_mfma_f32_32x32x16_bf16 v[96:111], v[128:131], v[72:75], v[96:111]
    v_mfma_f32_32x32x16_bf16 v[112:127], v[140:143], v[76:79], v[112:127]
    v_mfma_f32_32x32x16_bf16 v[96:111], v[136:139], v[76:79], v[96:111]
    s_bitcmp1_b32 s49, 6
    s_cbranch_scc0 L_ornd_58_ca
L_ornd_58_k6:
    ds_read_b64_tr_b16 v[128:129], v4 offset:24576
    ds_read_b64_tr_b16 v[130:131], v4 offset:25600
    ds_read_b64_tr_b16 v[132:133], v5 offset:24576
    ds_read_b64_tr_b16 v[134:135], v5 offset:25600
    ds_read_b64_tr_b16 v[136:137], v4 offset:26624
    ds_read_b64_tr_b16 v[138:139], v4 offset:27648
    ds_read_b64_tr_b16 v[140:141], v5 offset:26624
    ds_read_b64_tr_b16 v[142:143], v5 offset:27648
    s_waitcnt vmcnt(2)
    v_max3_u32 v13, v80, v81, v82
    v_max3_u32 v13, v13, v83, v84
    v_max3_u32 v13, v13, v85, v86
    v_max_u32 v13, v13, v87
    v_cmp_eq_u32 vcc, -1, v13
    s_bitset0_b32 s49, 6
    s_cmp_ge_u32 s51, 0x100000
    s_cbranch_scc1 L_ornd_58_g6
    s_nop 1
    s_cbranch_vccnz L_ornd_58_ca
L_ornd_58_g6:
    s_bitset0_b32 s50, 6
    s_waitcnt lgkmcnt(0)
    v_mfma_f32_32x32x16_bf16 v[112:127], v[132:135], v[80:83], v[112:127]
    v_mfma_f32_32x32x16_bf16 v[96:111], v[128:131], v[80:83], v[96:111]
    v_mfma_f32_32x32x16_bf16 v[112:127], v[140:143], v[84:87], v[112:127]
    v_mfma_f32_32x32x16_bf16 v[96:111], v[136:139], v[84:87], v[96:111]
    s_bitcmp1_b32 s49, 7
    s_cbranch_scc0 L_ornd_58_ca
L_ornd_58_k7:
    ds_read_b64_tr_b16 v[128:129], v4 offset:28672
    ds_read_b64_tr_b16 v[130:131], v4 offset:29696
    ds_read_b64_tr_b16 v[132:133], v5 offset:28672
    ds_read_b64_tr_b16 v[134:135], v5 offset:29696
    ds_read_b64_tr_b16 v[136:137], v4 offset:30720
    ds_read_b64_tr_b16 v[138:139], v4 offset:31744
    ds_read_b64_tr_b16 v[140:141], v5 offset:30720
    ds_read_b64_tr_b16 v[142:143], v5 offset:31744
    s_waitcnt vmcnt(0)
    v_max3_u32 v13, v88, v89, v90
    v_max3_u32 v13, v13, v91, v92
    v_max3_u32 v13, v13, v93, v94
    v_max_u32 v13, v13, v95
    v_cmp_eq_u32 vcc, -1, v13
    s_bitset0_b32 s49, 7
    s_cmp_ge_u32 s51, 0x100000
    s_cbranch_scc1 L_ornd_58_g7
    s_nop 1
    s_cbranch_vccnz L_ornd_58_ca
L_ornd_58_g7:
    s_bitset0_b32 s50, 7
    s_waitcnt lgkmcnt(0)
    v_mfma_f32_32x32x16_bf16 v[112:127], v[132:135], v[88:91], v[112:127]
    v_mfma_f32_32x32x16_bf16 v[96:111], v[128:131], v[88:91], v[96:111]
    v_mfma_f32_32x32x16_bf16 v[112:127], v[140:143], v[92:95], v[112:127]
    v_mfma_f32_32x32x16_bf16 v[96:111], v[136:139], v[92:95], v[96:111]
    s_branch L_ornd_58_ca
L_ornd_58_r:
    s_add_u32 s51, s51, 1
    s_branch L_ornd_58
L_code_end:
.section .rodata,"a"
.p2align 6
.amdhsa_kernel recurrent_scan__softmax_full_mha__dense_activation_relu__prompt_kernel
  .amdhsa_next_free_vgpr 168
  .amdhsa_next_free_sgpr 96
  .amdhsa_accum_offset 168
  .amdhsa_group_segment_fixed_size 0
  .amdhsa_kernarg_size 72
  .amdhsa_user_sgpr_count 2
  .amdhsa_user_sgpr_kernarg_segment_ptr 1
  .amdhsa_system_sgpr_workgroup_id_x 1
.end_amdhsa_kernel
```
